```python
import torch

def _softmax(x, axis=-1):
    return torch.softmax(x, dim=axis)
def _gelu(x):
    return torch.nn.functional.gelu(x, approximate="tanh")
def _silu(x):
    return torch.nn.functional.silu(x)
def _sigmoid(x):
    return torch.sigmoid(x)
def _layernorm(x, axis=-1, eps=1e-5):
    m = x.mean(dim=axis, keepdim=True)
    v = x.var(dim=axis, keepdim=True, unbiased=False)
    return (x - m) / torch.sqrt(v + eps)
def _scatter_add(tgt, idx, src, axis=0):
    return tgt.clone().index_add_(axis, idx, src)
def _segment_sum(src, seg, n):
    out = torch.zeros((n,) + src.shape[1:], dtype=src.dtype)
    return out.index_add_(0, seg, src)
def _pad(x, pw):
    flat = tuple(v for pair in reversed(pw) for v in pair)
    return torch.nn.functional.pad(x, flat)

kernel_name = 'recurrent_scan__sliding_block_cached__glu_gated_bilinear__decode'

def setup_inputs():

    _w = (lambda a: (lambda t: t.to(torch.bfloat16) if t.is_floating_point() else t)(torch.as_tensor(a)))
    def _A_setup():
        B, Sq, D = 2, 1, 448
        Hq, Hkv, Sk, Dh = 16, 8, 32768, 256
        assert Hq % Hkv == 0, (Hq, Hkv)
        return {
            "x": _w((lambda *s: torch.randn(*s, dtype=torch.bfloat16) * 0.2)(B, Sq, D)),
            "k_cache": _w((lambda *s: torch.randn(*s, dtype=torch.bfloat16) * 1.6)(B, Hkv, Sk, Dh)),
            "v_cache": _w((lambda *s: torch.randn(*s, dtype=torch.bfloat16) * 1.6)(B, Hkv, Sk, Dh)),
            "wq": _w((lambda *s: torch.randn(*s, dtype=torch.bfloat16) * 1.6)(D, Hq * Dh) * (D ** -0.5)),
            "wo": _w((lambda *s: torch.randn(*s, dtype=torch.bfloat16) * 1.6)(Hq * Dh, D) * ((Hq * Dh) ** -0.5)),
        }
    _A_in = _A_setup()

    def _B_setup():
        B, S, D, F = 2, 1, 448, 1792
        return {
            "x": _w((lambda *s: torch.randn(*s, dtype=torch.bfloat16) * 0.2)(B, S, D)),
            "w_gate": _w((lambda *s: torch.randn(*s, dtype=torch.bfloat16) * 0.8)(D, F) * (D ** -0.5)),
            "w_up": _w((lambda *s: torch.randn(*s, dtype=torch.bfloat16) * 0.8)(D, F) * (D ** -0.5)),
            "w_down": _w((lambda *s: torch.randn(*s, dtype=torch.bfloat16) * 0.8)(F, D) * (F ** -0.5)),
        }
    _B_in = _B_setup()

    return {
        "A_x": _A_in["x"],
        "A_k_cache": _A_in["k_cache"],
        "A_v_cache": _A_in["v_cache"],
        "A_wq": _A_in["wq"],
        "A_wo": _A_in["wo"],
        "B_x": _B_in["x"],
        "B_w_gate": _B_in["w_gate"],
        "B_w_up": _B_in["w_up"],
        "B_w_down": _B_in["w_down"],
    }

def reference(A_x, A_k_cache, A_v_cache, A_wq, A_wo, B_x, B_w_gate, B_w_up, B_w_down):
    def _A_ref(x, k_cache, v_cache, wq, wo):
        B, Sq, D = x.shape
        Hq, Dh = 16, 256
        Hkv, Sk = k_cache.shape[1], k_cache.shape[2]
        W = min(4096, max(256, Sk // 4))
        rep = Hq // Hkv
        q = (lambda x, *d: x.permute(*d))((x @ wq).reshape(B, Sq, Hq, Dh), 0, 2, 1, 3)
        k = (lambda x, n, axis: torch.repeat_interleave(x, n, dim=axis))(k_cache[:, :, Sk - W:, :], rep, axis=1)
        v = (lambda x, n, axis: torch.repeat_interleave(x, n, dim=axis))(v_cache[:, :, Sk - W:, :], rep, axis=1)
        scores = torch.einsum("bhqd,bhkd->bhqk", q, k) * (Dh ** -0.5)
        p = _softmax(scores, axis=-1)
        o = torch.einsum("bhqk,bhkd->bhqd", p, v)
        return (lambda x, *d: x.permute(*d))(o, 0, 2, 1, 3).reshape(B, Sq, Hq * Dh) @ wo

    def _B_ref(x, w_gate, w_up, w_down):
        g = torch.einsum("bsd,df->bsf", x, w_gate)
        u = torch.einsum("bsd,df->bsf", x, w_up)
        h = g * u
        return torch.einsum("bsf,fd->bsd", h, w_down)

    x = A_x
    xn = _layernorm(x, axis=-1)
    s = _A_ref(xn, A_k_cache, A_v_cache, A_wq, A_wo)
    g = _silu(_B_ref(xn, B_w_gate, B_w_up, B_w_down))
    return x + s * g
```

```asm
; @launch grid=(256,1,1) block=(1024,1,1) lds=163840
.amdgcn_target "amdgcn-amd-amdhsa--gfx950"
.text
.globl recurrent_scan__sliding_block_cached__glu_gated_bilinear__decode_kernel
.p2align 8
.type recurrent_scan__sliding_block_cached__glu_gated_bilinear__decode_kernel,@function
recurrent_scan__sliding_block_cached__glu_gated_bilinear__decode_kernel:
L_kstart:
    s_load_dwordx16 s[4:19], s[0:1], 0
    s_load_dwordx8 s[20:27], s[0:1], 64
    v_lshrrev_b32 v7, 6, v0
    v_and_b32 v1, 63, v0
    s_cmpk_ge_u32 s2, 0x100
    s_cbranch_scc1 L_exit
    v_readfirstlane_b32 s3, v7
    s_and_b32 s54, s2, 15
    s_lshl_b32 s54, s54, 24
    s_lshr_b32 s56, s2, 4
    s_lshl_b32 s55, s56, 17
    s_or_b32 s54, s54, s55
    s_setprio 3
    s_and_b32 s55, s3, 7
    s_lshl_b32 s55, s55, 14
    s_or_b32 s54, s54, s55
    s_or_b32 s53, s54, 0xe00000
    s_lshl_b32 s95, s3, 1
    s_add_u32 s95, s95, s56
    s_and_b32 s95, s95, 15
    s_sub_u32 s54, s2, 128
    s_cmpk_lt_u32 s54, 56
    s_cselect_b32 s51, 0, 2
    s_cmpk_lt_u32 s2, 64
    s_cselect_b32 s51, 0, s51
    s_cmpk_lt_u32 s3, 8
    s_cbranch_scc1 L_A
L_B:
    s_mov_b32 s63, 0
    s_cmp_ge_u32 s51, 2
    s_cbranch_scc1 L_B_light
    s_cmpk_eq_u32 s3, 15
    s_cbranch_scc1 L_B_nod
    s_sub_u32 s94, s3, 8
    v_lshrrev_b32 v11, 3, v1
    v_and_b32 v10, 7, v1
    v_lshlrev_b32 v10, 4, v10
    s_cmpk_lt_u32 s2, 64
    s_cbranch_scc0 L_B_gu
    s_and_b32 s52, s2, 7
    s_lshl_b32 s52, s52, 3
    s_lshr_b32 s54, s2, 3
    s_add_u32 s52, s52, s54
    s_movk_i32 s58, 0x2000
    s_mov_b32 s34, 0x380000
    s_lshl_b32 s59, s52, 9
    s_add_u32 s59, s59, 4096
    s_waitcnt lgkmcnt(0)
    s_mov_b32 s32, s10
    s_mov_b32 s33, s11
    s_branch L_B_d
L_B_gu:
    s_sub_u32 s52, s2, 128
    s_movk_i32 s58, 0xe00
    s_mov_b32 s34, 0x188000
    s_waitcnt lgkmcnt(0)
    s_mov_b32 s32, s16
    s_mov_b32 s33, s17
    s_mov_b32 s59, 36864
    s_cmpk_lt_u32 s52, 28
    s_cbranch_scc1 L_B_g
    s_mov_b32 s32, s18
    s_mov_b32 s33, s19
    s_sub_u32 s52, s52, 28
    s_mov_b32 s59, 51200
L_B_g:
    s_lshl_b32 s54, s52, 9
    s_add_u32 s59, s59, s54
L_B_d:
    s_mov_b32 s35, 0x20000
    s_lshl_b32 s54, s58, 3
    v_mul_u32_u24 v11, s54, v11
    v_add_u32 v10, v10, v11
    s_lshl_b32 s54, s94, 6
    s_mul_i32 s54, s54, s58
    s_lshl_b32 s60, s52, 7
    s_add_u32 s60, s60, s54
    s_mov_b32 s54, s60
    buffer_load_dwordx4 v[48:51], v10, s[32:35], s54 offen nt
    s_add_u32 s54, s54, s58
    buffer_load_dwordx4 v[52:55], v10, s[32:35], s54 offen nt
    s_add_u32 s54, s54, s58
    buffer_load_dwordx4 v[56:59], v10, s[32:35], s54 offen nt
    s_add_u32 s54, s54, s58
    buffer_load_dwordx4 v[60:63], v10, s[32:35], s54 offen nt
    s_add_u32 s54, s54, s58
    buffer_load_dwordx4 v[64:67], v10, s[32:35], s54 offen nt
    s_add_u32 s54, s54, s58
    buffer_load_dwordx4 v[68:71], v10, s[32:35], s54 offen nt
    s_add_u32 s54, s54, s58
    buffer_load_dwordx4 v[72:75], v10, s[32:35], s54 offen nt
    s_add_u32 s54, s54, s58
    buffer_load_dwordx4 v[76:79], v10, s[32:35], s54 offen nt
    s_mov_b32 s24, s94
    s_mov_b32 s40, s4
    s_mov_b32 s41, s5
    s_mov_b32 s42, 0x700
    s_mov_b32 s43, 0x20000
    v_lshrrev_b32 v7, 5, v1
    v_mul_u32_u24 v7, 896, v7
    v_and_b32 v9, 31, v1
    v_lshl_add_u32 v8, v9, 5, v7
    v_cmp_le_u32 vcc, 28, v9
    v_mov_b32 v9, 0x10000000
    s_nop 0
    v_cndmask_b32 v8, v8, v9, vcc
    buffer_load_dwordx4 v[80:83], v8, s[40:43], 0 offen
    buffer_load_dwordx4 v[84:87], v8, s[40:43], 0 offen offset:16
    v_bfe_u32 v7, v1, 1, 1
    v_mul_u32_u24 v7, 896, v7
    v_lshrrev_b32 v9, 4, v1
    v_lshl_add_u32 v7, v9, 5, v7
    v_and_b32 v9, 1, v1
    v_lshl_add_u32 v7, v9, 4, v7
    s_lshl_b32 s54, s24, 7
    buffer_load_dwordx4 v[92:95], v7, s[40:43], s54 offen
    s_barrier
    s_branch L_B2
L_A:
    v_mul_u32_u24 v2, 0x208, v1
    v_and_b32 v2, 0xe40, v2
    v_and_or_b32 v2, v1, 48, v2
    s_lshr_b32 s54, s95, 2
    s_lshl_b32 s54, s54, 12
    s_and_b32 s55, s95, 3
    s_lshl_b32 s55, s55, 7
    s_or_b32 s54, s54, s55
    s_xor_b32 s56, s53, s54
    s_mov_b32 s30, 0x10000000
    s_mov_b32 s31, 0x20000
    s_waitcnt lgkmcnt(0)
    s_mov_b32 s28, s6
    s_mov_b32 s29, s7
    s_cmp_ge_u32 s51, 2
    s_cbranch_scc1 L_if_1
    s_cmp_lg_u32 s3, 0
    s_cbranch_scc1 L_if_2
    v_mov_b32 v8, 0
    v_lshlrev_b32 v7, 2, v1
    v_add_u32 v7, 142592, v7
    ds_write_b32 v7, v8
    s_waitcnt lgkmcnt(0)
L_if_2:
    s_barrier
    s_setprio 2
L_if_1:
    s_xor_b32 s54, s56, 0
    buffer_load_dwordx4 v[16:19], v2, s[28:31], s54 offen nt
    s_xor_b32 s54, s56, 128
    buffer_load_dwordx4 v[20:23], v2, s[28:31], s54 offen nt
    s_xor_b32 s54, s56, 256
    buffer_load_dwordx4 v[24:27], v2, s[28:31], s54 offen nt
    s_xor_b32 s54, s56, 384
    buffer_load_dwordx4 v[28:31], v2, s[28:31], s54 offen nt
    s_xor_b32 s54, s56, 4096
    buffer_load_dwordx4 v[32:35], v2, s[28:31], s54 offen nt
    s_cmp_lt_u32 s51, 2
    s_cbranch_scc1 L_if_3
    s_cmp_lg_u32 s3, 0
    s_cbranch_scc1 L_if_4
    v_mov_b32 v8, 0
    v_lshlrev_b32 v7, 2, v1
    v_add_u32 v7, 142592, v7
    ds_write_b32 v7, v8
    s_waitcnt lgkmcnt(0)
L_if_4:
    s_barrier
L_if_3:
    s_xor_b32 s54, s56, 4224
    buffer_load_dwordx4 v[36:39], v2, s[28:31], s54 offen nt
    s_xor_b32 s54, s56, 4352
    buffer_load_dwordx4 v[40:43], v2, s[28:31], s54 offen nt
    s_xor_b32 s54, s56, 4480
    buffer_load_dwordx4 v[44:47], v2, s[28:31], s54 offen nt
    s_xor_b32 s54, s56, 8192
    buffer_load_dwordx4 v[48:51], v2, s[28:31], s54 offen nt
    s_xor_b32 s54, s56, 8320
    buffer_load_dwordx4 v[52:55], v2, s[28:31], s54 offen nt
    s_xor_b32 s54, s56, 8448
    buffer_load_dwordx4 v[56:59], v2, s[28:31], s54 offen nt
    s_xor_b32 s54, s56, 8576
    buffer_load_dwordx4 v[60:63], v2, s[28:31], s54 offen nt
    s_xor_b32 s54, s56, 12288
    buffer_load_dwordx4 v[64:67], v2, s[28:31], s54 offen nt
    s_xor_b32 s54, s56, 12416
    buffer_load_dwordx4 v[68:71], v2, s[28:31], s54 offen nt
    s_xor_b32 s54, s56, 12544
    buffer_load_dwordx4 v[72:75], v2, s[28:31], s54 offen nt
    s_xor_b32 s54, s56, 12672
    buffer_load_dwordx4 v[76:79], v2, s[28:31], s54 offen nt
    s_load_dword s48, s[26:27], 0
    s_mov_b32 s25, 0
    s_and_b32 s49, s2, 7
    s_lshr_b32 s50, s2, 3
    v_lshlrev_b32 v126, 4, v1
    s_mov_b32 s36, s26
    s_mov_b32 s37, s27
    s_mov_b32 s38, 0x40000000
    s_mov_b32 s39, 0x20000
    s_getpc_b64 s[98:99]
L_pc_5:
    s_sub_u32 s98, s98, L_pc_5-L_kstart
    s_subb_u32 s99, s99, 0
    s_lshl_b32 s54, s3, 10
    v_add_u32 v11, s54, v126
    v_min_u32 v11, L_exit-L_kstart-16, v11
    global_load_dwordx4 v[88:91], v11, s[98:99]
    s_setprio 3
    s_mov_b32 s51, 0
    s_lshl_b32 s52, s49, 3
    s_add_u32 s52, s52, s50
    s_cmp_lt_u32 s50, 8
    s_cbranch_scc1 L_rd_6
    s_mov_b32 s51, 3
    s_sub_u32 s52, s52, 8
    s_cmp_lt_u32 s50, 16
    s_cbranch_scc1 L_rd_6
    s_sub_u32 s52, s50, 16
    s_lshl_b32 s52, s52, 3
    s_add_u32 s52, s52, s49
    s_mov_b32 s51, 1
    s_cmp_lt_u32 s52, 56
    s_cbranch_scc1 L_rd_6
    s_mov_b32 s51, 2
    s_sub_u32 s52, s52, 56
    s_cmp_lt_u32 s52, 28
    s_cbranch_scc1 L_rd_6
    s_mov_b32 s51, 4
    s_sub_u32 s52, s52, 28
    s_cmp_lt_u32 s52, 28
    s_cbranch_scc1 L_rd_6
    s_mov_b32 s51, 5
L_rd_6:
    v_lshrrev_b32 v15, 4, v1
    v_and_b32 v14, 1, v1
    v_lshlrev_b32 v14, 9, v14
    v_lshl_add_u32 v14, v15, 4, v14
    v_add_u32 v123, 132096, v14
    v_and_b32 v11, 15, v1
    v_lshlrev_b32 v14, 3, v11
    v_lshl_add_u32 v122, v15, 16, v14
    v_and_b32 v11, 7, v1
    v_lshlrev_b32 v11, 3, v11
    v_and_b32 v15, 1, v15
    v_lshl_add_u32 v11, v15, 2, v11
    v_add_u32 v124, 133120, v11
    v_lshrrev_b32 v11, 2, v1
    v_and_b32 v15, 7, v11
    v_xor_b32 v15, s3, v15
    v_lshlrev_b32 v15, 5, v15
    v_lshl_add_u32 v11, v11, 9, v15
    v_and_b32 v14, 3, v1
    v_lshl_add_u32 v120, v14, 3, v11
    v_add_u32 v121, 0x10000, v120
    s_lshl_b32 s54, s49, 3
    s_lshr_b32 s55, s3, 2
    s_add_u32 s54, s54, s55
    s_lshl_b32 s54, s54, 14
    s_and_b32 s55, s50, 1
    s_lshl_b32 s55, s55, 13
    s_add_u32 s54, s54, s55
    s_lshr_b32 s55, s50, 1
    s_lshl_b32 s55, s55, 9
    s_add_u32 s54, s54, s55
    s_and_b32 s55, s3, 3
    s_lshl_b32 s55, s55, 7
    s_add_u32 s54, s54, s55
    s_add_u32 s61, s54, 1048576
    s_cmp_lg_u32 s51, 2
    s_cbranch_scc1 L_if_8
    s_mov_b32 s32, s20
    s_mov_b32 s33, s21
    s_mov_b32 s34, 0x188000
    s_mov_b32 s35, 0x20000
    s_sub_u32 s24, s3, 8
    s_mov_b32 s58, 896
    s_mul_i32 s60, s52, 57344
    s_lshl_b32 s54, s24, 7
    s_add_u32 s60, s60, s54
    v_lshrrev_b32 v11, 3, v1
    v_and_b32 v10, 7, v1
    v_lshlrev_b32 v10, 4, v10
    s_lshl_b32 s54, s58, 3
    v_mul_u32_u24 v11, s54, v11
    v_add_u32 v10, v10, v11
    v_bfe_u32 v7, v1, 1, 1
    v_lshlrev_b32 v7, 7, v7
    v_lshrrev_b32 v11, 4, v1
    v_lshl_add_u32 v7, v11, 5, v7
    v_and_b32 v11, 1, v1
    v_lshl_add_u32 v7, v11, 4, v7
    v_add_u32 v7, 133376, v7
    v_bfe_u32 v8, v1, 1, 2
    v_mul_u32_u24 v8, 7168, v8
    v_bfe_u32 v11, v1, 3, 1
    v_lshl_add_u32 v8, v11, 7, v8
    v_and_b32 v11, 1, v1
    v_lshl_add_u32 v8, v11, 6, v8
    v_lshrrev_b32 v11, 4, v1
    v_lshl_add_u32 v8, v11, 4, v8
    s_mul_i32 s54, s24, 28672
    s_lshl_b32 s101, s52, 8
    s_add_u32 s101, s101, s54
    s_add_u32 s101, s101, 73728
    s_branch L_rp_7
L_if_8:
    s_cmp_lg_u32 s51, 3
    s_cbranch_scc1 L_if_9
    s_mov_b32 s32, s12
    s_mov_b32 s33, s13
    s_mov_b32 s34, 0x380000
    s_mov_b32 s35, 0x20000
    s_sub_u32 s24, s3, 8
    s_mov_b32 s58, 896
    s_mul_i32 s60, s52, 57344
    s_lshl_b32 s54, s24, 7
    s_add_u32 s60, s60, s54
    v_lshrrev_b32 v11, 3, v1
    v_and_b32 v10, 7, v1
    v_lshlrev_b32 v10, 4, v10
    s_lshl_b32 s54, s58, 3
    v_mul_u32_u24 v11, s54, v11
    v_add_u32 v10, v10, v11
    v_bfe_u32 v12, v1, 1, 1
    v_lshlrev_b32 v12, 7, v12
    v_lshrrev_b32 v11, 4, v1
    v_lshl_add_u32 v12, v11, 5, v12
    v_and_b32 v11, 1, v1
    v_lshl_add_u32 v12, v11, 4, v12
    v_add_u32 v12, 133888, v12
    v_bfe_u32 v13, v1, 1, 2
    v_mul_u32_u24 v13, 16384, v13
    v_bfe_u32 v11, v1, 3, 1
    v_lshl_add_u32 v13, v11, 7, v13
    v_and_b32 v11, 1, v1
    v_lshl_add_u32 v13, v11, 6, v13
    v_lshrrev_b32 v11, 4, v1
    v_lshl_add_u32 v13, v11, 4, v13
    s_mul_i32 s54, s24, 65536
    s_lshl_b32 s14, s52, 8
    s_add_u32 s14, s14, s54
    s_add_u32 s14, s14, 274432
    v_and_b32 v14, 15, v1
    v_lshrrev_b32 v15, 4, v1
    v_lshlrev_b32 v11, 4, v15
    v_lshl_add_u32 v7, v14, 9, v11
    s_and_b32 s56, s3, 1
    s_lshr_b32 s59, s3, 1
    s_lshl_b32 s100, s52, 14
    s_lshl_b32 s54, s56, 13
    s_add_u32 s100, s100, s54
    s_lshl_b32 s54, s59, 6
    s_add_u32 s100, s100, s54
    s_add_u32 s100, s100, 1048576
    s_lshl_b32 s54, s56, 7
    s_lshl_b32 s55, s59, 4
    s_add_u32 s54, s54, s55
    s_add_u32 s54, s54, 133888
    v_lshl_add_u32 v9, v15, 2, s54
    s_branch L_rp_7
L_if_9:
    s_cmp_lg_u32 s51, 4
    s_cbranch_scc1 L_if_10
    s_mov_b32 s40, s4
    s_mov_b32 s41, s5
    s_mov_b32 s42, 0x700
    s_mov_b32 s43, 0x20000
    s_mov_b32 s44, s22
    s_mov_b32 s45, s23
    s_mov_b32 s46, 0x700
    s_mov_b32 s47, 0x20000
    v_bfe_u32 v7, v1, 4, 1
    v_mul_u32_u24 v7, 896, v7
    v_and_b32 v11, 15, v1
    v_lshl_add_u32 v7, v11, 1, v7
    s_lshl_b32 s54, s52, 5
    v_add_u32 v7, s54, v7
    s_lshl_b32 s54, s3, 7
    s_add_u32 s54, s54, 134400
    v_lshl_add_u32 v8, v1, 3, s54
    v_and_b32 v11, 31, v1
    v_lshlrev_b32 v11, 2, v11
    v_lshrrev_b32 v14, 5, v1
    v_lshl_add_u32 v9, v14, 9, v11
    v_add_u32 v9, 134400, v9
    s_mul_i32 s100, s52, 7168
    s_lshl_b32 s54, s3, 10
    s_add_u32 s100, s100, s54
    s_add_u32 s100, s100, 73728
    s_lshl_b32 s101, s52, 14
    s_lshl_b32 s54, s3, 11
    s_add_u32 s101, s101, s54
    s_add_u32 s101, s101, 274432
L_if_10:
L_rp_7:
    s_lshl_b32 s54, s49, 3
    s_add_u32 s54, s54, s3
    s_lshl_b32 s54, s54, 9
    s_and_b32 s55, s50, 1
    s_lshl_b32 s55, s55, 8
    s_add_u32 s54, s54, s55
    s_add_u32 s62, s54, 4096
    s_lshl_b32 s54, s3, 7
    s_add_u32 s54, s54, 131072
    v_lshl_add_u32 v2, v1, 2, s54
    v_bfe_u32 v11, v1, 1, 1
    v_lshlrev_b32 v11, 9, v11
    v_and_b32 v14, 1, v1
    v_lshl_add_u32 v11, v14, 6, v11
    v_lshrrev_b32 v15, 4, v1
    v_lshl_add_u32 v11, v15, 4, v11
    v_add_u32 v3, 131072, v11
    s_lshl_b32 s54, s3, 3
    s_add_u32 s54, s54, 133120
    v_mov_b32 v4, s54
    v_and_b32 v11, 7, v1
    v_lshlrev_b32 v11, 3, v11
    v_add_u32 v5, 133120, v11
    s_lshl_b32 s54, s3, 6
    s_add_u32 s54, s54, 132096
    v_and_b32 v11, 15, v1
    v_lshrrev_b32 v11, 2, v11
    v_lshlrev_b32 v11, 4, v11
    v_and_b32 v14, 3, v1
    v_lshl_add_u32 v11, v14, 1, v11
    v_add_u32 v6, s54, v11
    s_bfe_u32 s54, s95, 0x10002
    s_lshl_b32 s54, s54, 5
    s_bfe_u32 s55, s95, 0x10003
    s_lshl_b32 s55, s55, 3
    s_or_b32 s54, s54, s55
    v_xor_b32 v6, s54, v6
    v_xor_b32 v125, 8, v6
    s_and_b32 s54, s95, 3
    s_lshl_b32 s54, s54, 7
    v_xor_b32 v3, s54, v3
    s_waitcnt lgkmcnt(0)
    s_add_u32 s48, s48, 1
    s_cmp_lg_u32 s3, 7
    s_cbranch_scc1 L_if_11
    s_getreg_b32 s63, hwreg(HW_REG_XCC_ID, 0, 4)
    s_cmp_lg_u32 s51, 3
    s_cbranch_scc1 L_if_12
    s_lshl_b32 s54, s52, 3
    s_add_u32 s54, s54, 1024
    v_mov_b32 v116, s63
    v_mov_b32 v117, s48
    v_mov_b32 v11, 0
    s_mov_b64 exec, 1
    buffer_store_dwordx2 v[116:117], v11, s[36:39], s54 offen sc1
    s_mov_b64 exec, -1
L_if_12:
L_if_11:
    s_waitcnt vmcnt(0)
    s_mov_b32 s57, 20000
L_ps_13:
    s_load_dwordx16 s[64:79], s[26:27], s62 offset:0 glc
    s_load_dwordx16 s[80:95], s[26:27], s62 offset:64 glc
    s_waitcnt lgkmcnt(0)
    s_and_b32 s55, s65, s67
    s_or_b32 s56, s65, s67
    s_and_b32 s55, s55, s69
    s_or_b32 s56, s56, s69
    s_and_b32 s55, s55, s71
    s_or_b32 s56, s56, s71
    s_and_b32 s55, s55, s73
    s_or_b32 s56, s56, s73
    s_and_b32 s55, s55, s75
    s_or_b32 s56, s56, s75
    s_and_b32 s55, s55, s77
    s_or_b32 s56, s56, s77
    s_and_b32 s55, s55, s79
    s_or_b32 s56, s56, s79
    s_and_b32 s55, s55, s81
    s_or_b32 s56, s56, s81
    s_and_b32 s55, s55, s83
    s_or_b32 s56, s56, s83
    s_and_b32 s55, s55, s85
    s_or_b32 s56, s56, s85
    s_and_b32 s55, s55, s87
    s_or_b32 s56, s56, s87
    s_and_b32 s55, s55, s89
    s_or_b32 s56, s56, s89
    s_and_b32 s55, s55, s91
    s_or_b32 s56, s56, s91
    s_and_b32 s55, s55, s93
    s_or_b32 s56, s56, s93
    s_and_b32 s55, s55, s95
    s_or_b32 s56, s56, s95
    s_xor_b32 s55, s55, s48
    s_xor_b32 s56, s56, s48
    s_or_b32 s55, s55, s56
    s_cbranch_scc0 L_pd_14
    s_sleep 2
    s_sub_u32 s57, s57, 1
    s_cmp_lg_u32 s57, 0
    s_cbranch_scc1 L_ps_13
L_pd_14:
    v_writelane_b32 v11, s64, 0
    v_writelane_b32 v11, s66, 1
    v_writelane_b32 v11, s68, 2
    v_writelane_b32 v11, s70, 3
    v_writelane_b32 v11, s72, 4
    v_writelane_b32 v11, s74, 5
    v_writelane_b32 v11, s76, 6
    v_writelane_b32 v11, s78, 7
    v_writelane_b32 v11, s80, 8
    v_writelane_b32 v11, s82, 9
    v_writelane_b32 v11, s84, 10
    v_writelane_b32 v11, s86, 11
    v_writelane_b32 v11, s88, 12
    v_writelane_b32 v11, s90, 13
    v_writelane_b32 v11, s92, 14
    v_writelane_b32 v11, s94, 15
    s_mov_b32 exec_lo, 0xffff
    s_mov_b32 exec_hi, 0
    ds_write_b32 v2, v11
    s_mov_b64 exec, -1
    v_add_u32 v2, 64, v2
    s_mov_b32 s57, 20000
L_ps_15:
    s_load_dwordx16 s[64:79], s[26:27], s62 offset:128 glc
    s_load_dwordx16 s[80:95], s[26:27], s62 offset:192 glc
    s_waitcnt lgkmcnt(0)
    s_and_b32 s55, s65, s67
    s_or_b32 s56, s65, s67
    s_and_b32 s55, s55, s69
    s_or_b32 s56, s56, s69
    s_and_b32 s55, s55, s71
    s_or_b32 s56, s56, s71
    s_and_b32 s55, s55, s73
    s_or_b32 s56, s56, s73
    s_and_b32 s55, s55, s75
    s_or_b32 s56, s56, s75
    s_and_b32 s55, s55, s77
    s_or_b32 s56, s56, s77
    s_and_b32 s55, s55, s79
    s_or_b32 s56, s56, s79
    s_and_b32 s55, s55, s81
    s_or_b32 s56, s56, s81
    s_and_b32 s55, s55, s83
    s_or_b32 s56, s56, s83
    s_and_b32 s55, s55, s85
    s_or_b32 s56, s56, s85
    s_and_b32 s55, s55, s87
    s_or_b32 s56, s56, s87
    s_and_b32 s55, s55, s89
    s_or_b32 s56, s56, s89
    s_and_b32 s55, s55, s91
    s_or_b32 s56, s56, s91
    s_and_b32 s55, s55, s93
    s_or_b32 s56, s56, s93
    s_and_b32 s55, s55, s95
    s_or_b32 s56, s56, s95
    s_xor_b32 s55, s55, s48
    s_xor_b32 s56, s56, s48
    s_or_b32 s55, s55, s56
    s_cbranch_scc0 L_pd_16
    s_sleep 2
    s_sub_u32 s57, s57, 1
    s_cmp_lg_u32 s57, 0
    s_cbranch_scc1 L_ps_15
L_pd_16:
    v_writelane_b32 v11, s64, 0
    v_writelane_b32 v11, s66, 1
    v_writelane_b32 v11, s68, 2
    v_writelane_b32 v11, s70, 3
    v_writelane_b32 v11, s72, 4
    v_writelane_b32 v11, s74, 5
    v_writelane_b32 v11, s76, 6
    v_writelane_b32 v11, s78, 7
    v_writelane_b32 v11, s80, 8
    v_writelane_b32 v11, s82, 9
    v_writelane_b32 v11, s84, 10
    v_writelane_b32 v11, s86, 11
    v_writelane_b32 v11, s88, 12
    v_writelane_b32 v11, s90, 13
    v_writelane_b32 v11, s92, 14
    v_writelane_b32 v11, s94, 15
    s_mov_b32 exec_lo, 0xffff
    s_mov_b32 exec_hi, 0
    ds_write_b32 v2, v11
    s_mov_b64 exec, -1
    s_waitcnt lgkmcnt(0)
    v_mov_b32 v11, 142624
    v_mov_b32 v14, 1
    s_mov_b64 exec, 1
    ds_add_u32 v11, v14
    s_mov_b64 exec, -1
    v_mov_b32 v11, 142624
    s_mov_b32 s57, 1000000
L_sw_17:
    ds_read_b32 v14, v11
    s_waitcnt lgkmcnt(0)
    v_cmp_gt_u32 vcc, 8, v14
    s_nop 0
    s_cbranch_vccz L_swd_18
    s_sub_u32 s57, s57, 1
    s_cmp_lg_u32 s57, 0
    s_cbranch_scc1 L_sw_17
L_swd_18:
    ds_read_b128 v[96:99], v3
    v_xor_b32 v14, 128, v3
    ds_read_b128 v[100:103], v14
    v_xor_b32 v14, 256, v3
    ds_read_b128 v[104:107], v14
    v_xor_b32 v14, 384, v3
    ds_read_b128 v[108:111], v14
    s_waitcnt vmcnt(0) lgkmcnt(0)
    v_mfma_f32_16x16x32_bf16 v[80:83], v[96:99], v[16:19], 0
    v_mfma_f32_16x16x32_bf16 v[84:87], v[96:99], v[32:35], 0
    v_mfma_f32_16x16x32_bf16 v[88:91], v[96:99], v[48:51], 0
    v_mfma_f32_16x16x32_bf16 v[92:95], v[96:99], v[64:67], 0
    v_mfma_f32_16x16x32_bf16 v[80:83], v[100:103], v[20:23], v[80:83]
    v_mfma_f32_16x16x32_bf16 v[84:87], v[100:103], v[36:39], v[84:87]
    v_mfma_f32_16x16x32_bf16 v[88:91], v[100:103], v[52:55], v[88:91]
    v_mfma_f32_16x16x32_bf16 v[92:95], v[100:103], v[68:71], v[92:95]
    v_mfma_f32_16x16x32_bf16 v[80:83], v[104:107], v[24:27], v[80:83]
    v_mfma_f32_16x16x32_bf16 v[84:87], v[104:107], v[40:43], v[84:87]
    v_mfma_f32_16x16x32_bf16 v[88:91], v[104:107], v[56:59], v[88:91]
    v_mfma_f32_16x16x32_bf16 v[92:95], v[104:107], v[72:75], v[92:95]
    v_mfma_f32_16x16x32_bf16 v[80:83], v[108:111], v[28:31], v[80:83]
    v_mfma_f32_16x16x32_bf16 v[84:87], v[108:111], v[44:47], v[84:87]
    v_mfma_f32_16x16x32_bf16 v[88:91], v[108:111], v[60:63], v[88:91]
    v_mfma_f32_16x16x32_bf16 v[92:95], v[108:111], v[76:79], v[92:95]
    s_nop 4
    v_add_f32_dpp v112, v81, v80 row_ror:8 row_mask:0xf bank_mask:0x3
    v_add_f32_dpp v113, v83, v82 row_ror:8 row_mask:0xf bank_mask:0x3
    v_add_f32_dpp v114, v89, v88 row_ror:8 row_mask:0xf bank_mask:0x3
    v_add_f32_dpp v115, v91, v90 row_ror:8 row_mask:0xf bank_mask:0x3
    v_add_f32_dpp v112, v84, v85 row_ror:8 row_mask:0xf bank_mask:0xc
    v_add_f32_dpp v113, v86, v87 row_ror:8 row_mask:0xf bank_mask:0xc
    v_add_f32_dpp v114, v92, v93 row_ror:8 row_mask:0xf bank_mask:0xc
    v_add_f32_dpp v115, v94, v95 row_ror:8 row_mask:0xf bank_mask:0xc
    v_cvt_pk_bf16_f32 v96, v112, v113
    v_cvt_pk_bf16_f32 v97, v114, v115
    v_lshlrev_b32 v112, 16, v96
    v_and_b32 v113, 0xffff0000, v96
    v_lshlrev_b32 v114, 16, v97
    v_and_b32 v115, 0xffff0000, v97
    v_max_f32 v116, v112, v114
    v_max_f32 v117, v113, v115
    s_nop 0
    v_max_f32_dpp v116, v116, v116 row_ror:8 row_mask:0xf bank_mask:0xf
    v_max_f32_dpp v117, v117, v117 row_ror:8 row_mask:0xf bank_mask:0xf
    s_nop 0
    v_max_f32_dpp v116, v116, v116 row_ror:4 row_mask:0xf bank_mask:0xf
    v_max_f32_dpp v117, v117, v117 row_ror:4 row_mask:0xf bank_mask:0xf
    s_nop 0
    v_max_f32_dpp v116, v116, v116 row_ror:2 row_mask:0xf bank_mask:0xf
    v_max_f32_dpp v117, v117, v117 row_ror:2 row_mask:0xf bank_mask:0xf
    s_nop 0
    v_max_f32_dpp v116, v116, v116 row_ror:1 row_mask:0xf bank_mask:0xf
    v_max_f32_dpp v117, v117, v117 row_ror:1 row_mask:0xf bank_mask:0xf
    s_mov_b64 exec, 1
    ds_write_b64 v4, v[116:117]
    s_mov_b64 exec, -1
    s_waitcnt lgkmcnt(0)
    v_mov_b32 v11, 142628
    v_mov_b32 v14, 1
    s_mov_b64 exec, 1
    ds_add_u32 v11, v14
    s_mov_b64 exec, -1
    v_mov_b32 v11, 142628
    s_mov_b32 s57, 1000000
L_sw_19:
    ds_read_b32 v14, v11
    s_waitcnt lgkmcnt(0)
    v_cmp_gt_u32 vcc, 8, v14
    s_nop 0
    s_cbranch_vccz L_swd_20
    s_sub_u32 s57, s57, 1
    s_cmp_lg_u32 s57, 0
    s_cbranch_scc1 L_sw_19
L_swd_20:
    ds_read_b64 v[116:117], v5
    s_waitcnt lgkmcnt(0)
    v_max_f32_dpp v116, v116, v116 row_ror:4 row_mask:0xf bank_mask:0xf
    v_max_f32_dpp v117, v117, v117 row_ror:4 row_mask:0xf bank_mask:0xf
    s_nop 0
    v_max_f32_dpp v116, v116, v116 row_ror:2 row_mask:0xf bank_mask:0xf
    v_max_f32_dpp v117, v117, v117 row_ror:2 row_mask:0xf bank_mask:0xf
    s_nop 0
    v_max_f32_dpp v116, v116, v116 row_ror:1 row_mask:0xf bank_mask:0xf
    v_max_f32_dpp v117, v117, v117 row_ror:1 row_mask:0xf bank_mask:0xf
    v_sub_f32 v100, v112, v116
    v_sub_f32 v101, v113, v117
    v_sub_f32 v102, v114, v116
    v_sub_f32 v103, v115, v117
    v_mul_f32 v100, 0x3db8aa3b, v100
    v_mul_f32 v101, 0x3db8aa3b, v101
    v_mul_f32 v102, 0x3db8aa3b, v102
    v_mul_f32 v103, 0x3db8aa3b, v103
    v_exp_f32 v100, v100
    v_exp_f32 v101, v101
    v_exp_f32 v102, v102
    v_exp_f32 v103, v103
    v_cvt_pk_bf16_f32 v96, v100, v101
    v_cvt_pk_bf16_f32 v97, v102, v103
    v_add_f32 v104, v100, v102
    v_add_f32 v105, v101, v103
    s_mov_b32 exec_lo, 0xffff
    s_mov_b32 exec_hi, 0
    ds_write_b16 v6, v96
    ds_write_b16_d16_hi v6, v96 offset:512
    ds_write_b16 v125, v97
    ds_write_b16_d16_hi v125, v97 offset:512
    s_mov_b64 exec, -1
    v_add_f32_dpp v104, v104, v104 row_ror:8 row_mask:0xf bank_mask:0xf
    v_add_f32_dpp v105, v105, v105 row_ror:8 row_mask:0xf bank_mask:0xf
    s_nop 0
    v_add_f32_dpp v104, v104, v104 row_ror:4 row_mask:0xf bank_mask:0xf
    v_add_f32_dpp v105, v105, v105 row_ror:4 row_mask:0xf bank_mask:0xf
    s_nop 0
    v_add_f32_dpp v104, v104, v104 row_ror:2 row_mask:0xf bank_mask:0xf
    v_add_f32_dpp v105, v105, v105 row_ror:2 row_mask:0xf bank_mask:0xf
    s_nop 0
    v_add_f32_dpp v104, v104, v104 row_ror:1 row_mask:0xf bank_mask:0xf
    v_add_f32_dpp v105, v105, v105 row_ror:1 row_mask:0xf bank_mask:0xf
    s_mov_b64 exec, 1
    ds_write_b64 v4, v[104:105] offset:128
    s_mov_b64 exec, -1
    s_cmp_lg_u32 s51, 2
    s_cbranch_scc1 L_if_21
    s_lshl_b32 s54, s52, 9
    s_lshl_b32 s55, s3, 6
    s_add_u32 s54, s54, s55
    s_add_u32 s15, s54, 51200
    s_add_u32 s62, s54, 36864
    v_and_b32 v2, 7, v1
    v_lshlrev_b32 v2, 2, v2
    v_bfe_u32 v15, v1, 3, 1
    v_lshl_add_u32 v2, v15, 8, v2
    s_lshl_b32 s54, s3, 5
    s_add_u32 s54, s54, 133376
    v_add_u32 v2, s54, v2
    s_mov_b32 s57, 20000
L_ps_22:
    s_load_dwordx16 s[64:79], s[26:27], s62 offset:0 glc
    s_load_dwordx16 s[80:95], s[26:27], s15 offset:0 glc
    s_waitcnt lgkmcnt(0)
    s_and_b32 s55, s65, s67
    s_or_b32 s56, s65, s67
    s_and_b32 s55, s55, s69
    s_or_b32 s56, s56, s69
    s_and_b32 s55, s55, s71
    s_or_b32 s56, s56, s71
    s_and_b32 s55, s55, s73
    s_or_b32 s56, s56, s73
    s_and_b32 s55, s55, s75
    s_or_b32 s56, s56, s75
    s_and_b32 s55, s55, s77
    s_or_b32 s56, s56, s77
    s_and_b32 s55, s55, s79
    s_or_b32 s56, s56, s79
    s_and_b32 s55, s55, s81
    s_or_b32 s56, s56, s81
    s_and_b32 s55, s55, s83
    s_or_b32 s56, s56, s83
    s_and_b32 s55, s55, s85
    s_or_b32 s56, s56, s85
    s_and_b32 s55, s55, s87
    s_or_b32 s56, s56, s87
    s_and_b32 s55, s55, s89
    s_or_b32 s56, s56, s89
    s_and_b32 s55, s55, s91
    s_or_b32 s56, s56, s91
    s_and_b32 s55, s55, s93
    s_or_b32 s56, s56, s93
    s_and_b32 s55, s55, s95
    s_or_b32 s56, s56, s95
    s_xor_b32 s55, s55, s48
    s_xor_b32 s56, s56, s48
    s_or_b32 s55, s55, s56
    s_cbranch_scc0 L_pd_23
    s_sleep 2
    s_sub_u32 s57, s57, 1
    s_cmp_lg_u32 s57, 0
    s_cbranch_scc1 L_ps_22
L_pd_23:
    v_writelane_b32 v11, s64, 0
    v_writelane_b32 v11, s66, 1
    v_writelane_b32 v11, s68, 2
    v_writelane_b32 v11, s70, 3
    v_writelane_b32 v11, s72, 4
    v_writelane_b32 v11, s74, 5
    v_writelane_b32 v11, s76, 6
    v_writelane_b32 v11, s78, 7
    v_writelane_b32 v11, s80, 8
    v_writelane_b32 v11, s82, 9
    v_writelane_b32 v11, s84, 10
    v_writelane_b32 v11, s86, 11
    v_writelane_b32 v11, s88, 12
    v_writelane_b32 v11, s90, 13
    v_writelane_b32 v11, s92, 14
    v_writelane_b32 v11, s94, 15
    s_mov_b32 exec_lo, 0xffff
    s_mov_b32 exec_hi, 0
    ds_write_b32 v2, v11
    s_mov_b64 exec, -1
L_if_21:
    s_cmp_lg_u32 s3, 7
    s_cbranch_scc1 L_if_24
    s_lshl_b32 s62, s49, 6
    s_add_u32 s62, s62, 1024
    s_mov_b32 s57, 20000
L_ps_25:
    s_load_dwordx16 s[64:79], s[26:27], s62 offset:0 glc
    s_waitcnt lgkmcnt(0)
    s_and_b32 s55, s65, s67
    s_or_b32 s56, s65, s67
    s_and_b32 s55, s55, s69
    s_or_b32 s56, s56, s69
    s_and_b32 s55, s55, s71
    s_or_b32 s56, s56, s71
    s_and_b32 s55, s55, s73
    s_or_b32 s56, s56, s73
    s_and_b32 s55, s55, s75
    s_or_b32 s56, s56, s75
    s_and_b32 s55, s55, s77
    s_or_b32 s56, s56, s77
    s_and_b32 s55, s55, s79
    s_or_b32 s56, s56, s79
    s_xor_b32 s55, s55, s48
    s_xor_b32 s56, s56, s48
    s_or_b32 s55, s55, s56
    s_cbranch_scc0 L_pd_26
    s_sleep 2
    s_sub_u32 s57, s57, 1
    s_cmp_lg_u32 s57, 0
    s_cbranch_scc1 L_ps_25
L_pd_26:
    s_xor_b32 s56, s64, s63
    s_xor_b32 s55, s66, s63
    s_or_b32 s56, s56, s55
    s_xor_b32 s55, s68, s63
    s_or_b32 s56, s56, s55
    s_xor_b32 s55, s70, s63
    s_or_b32 s56, s56, s55
    s_xor_b32 s55, s72, s63
    s_or_b32 s56, s56, s55
    s_xor_b32 s55, s74, s63
    s_or_b32 s56, s56, s55
    s_xor_b32 s55, s76, s63
    s_or_b32 s56, s56, s55
    s_xor_b32 s55, s78, s63
    s_or_b32 s56, s56, s55
    s_cmp_eq_u32 s56, 0
    s_cselect_b32 s56, 1, 0
    s_cmp_eq_u32 s65, s48
    s_cselect_b32 s56, s56, 0
    v_mov_b32 v11, 142636
    v_mov_b32 v14, s56
    s_mov_b64 exec, 1
    ds_write_b32 v11, v14
    s_mov_b64 exec, -1
L_if_24:
    s_waitcnt lgkmcnt(0)
    v_mov_b32 v11, 142632
    v_mov_b32 v14, 1
    s_mov_b64 exec, 1
    ds_add_u32 v11, v14
    s_mov_b64 exec, -1
    s_branch L_JOIN
L_B2:
    s_load_dword s48, s[26:27], 0
    s_mov_b32 s25, 0
    v_lshrrev_b32 v7, 5, v1
    v_and_b32 v8, 31, v1
    v_lshlrev_b32 v9, 1, v7
    v_xor_b32 v8, v8, v9
    v_lshlrev_b32 v8, 4, v8
    v_lshl_add_u32 v3, v7, 9, v8
    s_and_b32 s54, s95, 3
    s_lshl_b32 s54, s54, 6
    v_xor_b32 v3, s54, v3
    v_xor_b32 v4, 64, v3
    v_xor_b32 v5, 0x80, v3
    v_xor_b32 v6, 0xc0, v3
    s_and_b32 s100, s3, 7
    s_lshl_b32 s100, s100, 14
    s_lshl_b32 s54, s95, 10
    s_xor_b32 s100, s100, s54
    s_xor_b32 s101, s53, s54
    s_mov_b32 s30, 0x10000000
    s_mov_b32 s31, 0x20000
    s_and_b32 s49, s2, 7
    s_lshr_b32 s50, s2, 3
    v_lshlrev_b32 v126, 4, v1
    s_mov_b32 s36, s26
    s_mov_b32 s37, s27
    s_mov_b32 s38, 0x40000000
    s_mov_b32 s39, 0x20000
    s_waitcnt vmcnt(0)
    v_lshlrev_b32 v96, 16, v80
    v_and_b32 v97, 0xffff0000, v80
    v_lshlrev_b32 v98, 16, v81
    v_and_b32 v99, 0xffff0000, v81
    v_lshlrev_b32 v100, 16, v82
    v_and_b32 v101, 0xffff0000, v82
    v_lshlrev_b32 v102, 16, v83
    v_and_b32 v103, 0xffff0000, v83
    v_lshlrev_b32 v104, 16, v84
    v_and_b32 v105, 0xffff0000, v84
    v_lshlrev_b32 v106, 16, v85
    v_and_b32 v107, 0xffff0000, v85
    v_lshlrev_b32 v108, 16, v86
    v_and_b32 v109, 0xffff0000, v86
    v_lshlrev_b32 v110, 16, v87
    v_and_b32 v111, 0xffff0000, v87
    v_add_f32 v116, v96, v97
    v_add_f32 v117, v98, v99
    v_add_f32 v118, v100, v101
    v_add_f32 v119, v102, v103
    v_add_f32 v116, v116, v104
    v_add_f32 v117, v117, v106
    v_add_f32 v118, v118, v108
    v_add_f32 v119, v119, v110
    v_add_f32 v116, v116, v105
    v_add_f32 v117, v117, v107
    v_add_f32 v118, v118, v109
    v_add_f32 v119, v119, v111
    v_add_f32 v116, v116, v117
    v_add_f32 v118, v118, v119
    v_add_f32 v116, v116, v118
    s_nop 1
    v_add_f32_dpp v116, v116, v116 row_ror:8 row_mask:0xf bank_mask:0xf
    s_nop 1
    v_add_f32_dpp v116, v116, v116 row_ror:4 row_mask:0xf bank_mask:0xf
    s_nop 1
    v_add_f32_dpp v116, v116, v116 row_ror:2 row_mask:0xf bank_mask:0xf
    s_nop 1
    v_add_f32_dpp v116, v116, v116 row_ror:1 row_mask:0xf bank_mask:0xf
    v_mov_b32 v117, v116
    s_nop 1
    v_permlane16_swap_b32 v116, v117
    v_add_f32 v116, v116, v117
    v_mul_f32 v116, 0x3b124925, v116
    v_sub_f32 v96, v96, v116
    v_sub_f32 v97, v97, v116
    v_sub_f32 v98, v98, v116
    v_sub_f32 v99, v99, v116
    v_sub_f32 v100, v100, v116
    v_sub_f32 v101, v101, v116
    v_sub_f32 v102, v102, v116
    v_sub_f32 v103, v103, v116
    v_sub_f32 v104, v104, v116
    v_sub_f32 v105, v105, v116
    v_sub_f32 v106, v106, v116
    v_sub_f32 v107, v107, v116
    v_sub_f32 v108, v108, v116
    v_sub_f32 v109, v109, v116
    v_sub_f32 v110, v110, v116
    v_sub_f32 v111, v111, v116
    v_mul_f32 v117, v96, v96
    v_mul_f32 v118, v97, v97
    v_mul_f32 v119, v98, v98
    v_mul_f32 v11, v99, v99
    v_fmac_f32 v117, v100, v100
    v_fmac_f32 v118, v101, v101
    v_fmac_f32 v119, v102, v102
    v_fmac_f32 v11, v103, v103
    v_fmac_f32 v117, v104, v104
    v_fmac_f32 v118, v105, v105
    v_fmac_f32 v119, v106, v106
    v_fmac_f32 v11, v107, v107
    v_fmac_f32 v117, v108, v108
    v_fmac_f32 v118, v109, v109
    v_fmac_f32 v119, v110, v110
    v_fmac_f32 v11, v111, v111
    v_add_f32 v117, v117, v118
    v_add_f32 v119, v119, v11
    v_add_f32 v117, v117, v119
    s_mov_b32 s98, 0xfffffff
    s_mov_b32 s99, 0xfffffff
    v_cndmask_b32 v117, 0, v117, s[98:99]
    s_nop 1
    v_add_f32_dpp v117, v117, v117 row_ror:8 row_mask:0xf bank_mask:0xf
    s_nop 1
    v_add_f32_dpp v117, v117, v117 row_ror:4 row_mask:0xf bank_mask:0xf
    s_nop 1
    v_add_f32_dpp v117, v117, v117 row_ror:2 row_mask:0xf bank_mask:0xf
    s_nop 1
    v_add_f32_dpp v117, v117, v117 row_ror:1 row_mask:0xf bank_mask:0xf
    v_mov_b32 v118, v117
    s_nop 1
    v_permlane16_swap_b32 v117, v118
    v_add_f32 v117, v117, v118
    v_mul_f32 v117, 0x3b124925, v117
    v_cvt_pk_bf16_f32 v116, v116, v116
    v_lshlrev_b32 v116, 16, v116
    v_cvt_pk_bf16_f32 v117, v117, v117
    v_lshlrev_b32 v117, 16, v117
    v_add_f32 v117, 0x3727c5ac, v117
    v_cvt_pk_bf16_f32 v117, v117, v117
    v_lshlrev_b32 v117, 16, v117
    v_sqrt_f32 v117, v117
    s_nop 0
    v_cvt_pk_bf16_f32 v117, v117, v117
    v_lshlrev_b32 v117, 16, v117
    v_mov_b32 v118, v116
    v_mov_b32 v119, v117
    s_nop 0
    v_permlane32_swap_b32 v116, v118
    v_permlane32_swap_b32 v117, v119
    s_mov_b32 s98, 0xcccccccc
    s_mov_b32 s99, 0xcccccccc
    v_cndmask_b32 v116, v116, v118, s[98:99]
    v_cndmask_b32 v117, v117, v119, s[98:99]
    v_rcp_f32 v118, v117
    v_lshlrev_b32 v96, 16, v92
    v_and_b32 v97, 0xffff0000, v92
    v_lshlrev_b32 v98, 16, v93
    v_and_b32 v99, 0xffff0000, v93
    v_lshlrev_b32 v100, 16, v94
    v_and_b32 v101, 0xffff0000, v94
    v_lshlrev_b32 v102, 16, v95
    v_and_b32 v103, 0xffff0000, v95
    v_sub_f32 v96, v96, v116
    v_sub_f32 v97, v97, v116
    v_sub_f32 v98, v98, v116
    v_sub_f32 v99, v99, v116
    v_sub_f32 v100, v100, v116
    v_sub_f32 v101, v101, v116
    v_sub_f32 v102, v102, v116
    v_sub_f32 v103, v103, v116
    v_cvt_pk_bf16_f32 v92, v96, v97
    v_cvt_pk_bf16_f32 v93, v98, v99
    v_cvt_pk_bf16_f32 v94, v100, v101
    v_cvt_pk_bf16_f32 v95, v102, v103
    v_lshlrev_b32 v96, 16, v92
    v_and_b32 v97, 0xffff0000, v92
    v_lshlrev_b32 v98, 16, v93
    v_and_b32 v99, 0xffff0000, v93
    v_lshlrev_b32 v100, 16, v94
    v_and_b32 v101, 0xffff0000, v94
    v_lshlrev_b32 v102, 16, v95
    v_and_b32 v103, 0xffff0000, v95
    v_mul_f32 v104, v96, v118
    v_mul_f32 v105, v97, v118
    v_mul_f32 v106, v98, v118
    v_mul_f32 v107, v99, v118
    v_mul_f32 v108, v100, v118
    v_mul_f32 v109, v101, v118
    v_mul_f32 v110, v102, v118
    v_mul_f32 v111, v103, v118
    v_fma_f32 v80, -v104, v117, v96
    v_fma_f32 v81, -v105, v117, v97
    v_fma_f32 v82, -v106, v117, v98
    v_fma_f32 v83, -v107, v117, v99
    v_fma_f32 v84, -v108, v117, v100
    v_fma_f32 v85, -v109, v117, v101
    v_fma_f32 v86, -v110, v117, v102
    v_fma_f32 v87, -v111, v117, v103
    v_fmac_f32 v104, v80, v118
    v_fmac_f32 v105, v81, v118
    v_fmac_f32 v106, v82, v118
    v_fmac_f32 v107, v83, v118
    v_fmac_f32 v108, v84, v118
    v_fmac_f32 v109, v85, v118
    v_fmac_f32 v110, v86, v118
    v_fmac_f32 v111, v87, v118
    v_cvt_pk_bf16_f32 v112, v104, v105
    v_cvt_pk_bf16_f32 v113, v106, v107
    v_cvt_pk_bf16_f32 v114, v108, v109
    v_cvt_pk_bf16_f32 v115, v110, v111
    v_bfe_u32 v12, v1, 3, 1
    v_lshlrev_b32 v12, 8, v12
    v_and_b32 v13, 7, v1
    v_lshl_add_u32 v12, v13, 5, v12
    v_lshrrev_b32 v13, 4, v1
    v_lshl_add_u32 v12, v13, 3, v12
    s_lshl_b32 s54, s24, 9
    s_add_u32 s54, s54, 138496
    v_add_u32 v12, s54, v12
    s_waitcnt vmcnt(0)
    s_mov_b32 s96, 0x05040100
    s_mov_b32 s97, 0x07060302
    v_perm_b32 v80, v52, v48, s96
    v_perm_b32 v81, v60, v56, s96
    v_perm_b32 v82, v68, v64, s96
    v_perm_b32 v83, v76, v72, s96
    v_perm_b32 v84, v52, v48, s97
    v_perm_b32 v85, v60, v56, s97
    v_perm_b32 v86, v68, v64, s97
    v_perm_b32 v87, v76, v72, s97
    v_perm_b32 v88, v53, v49, s96
    v_perm_b32 v89, v61, v57, s96
    v_perm_b32 v90, v69, v65, s96
    v_perm_b32 v91, v77, v73, s96
    v_perm_b32 v92, v53, v49, s97
    v_perm_b32 v93, v61, v57, s97
    v_perm_b32 v94, v69, v65, s97
    v_perm_b32 v95, v77, v73, s97
    v_perm_b32 v96, v54, v50, s96
    v_perm_b32 v97, v62, v58, s96
    v_perm_b32 v98, v70, v66, s96
    v_perm_b32 v99, v78, v74, s96
    v_perm_b32 v100, v54, v50, s97
    v_perm_b32 v101, v62, v58, s97
    v_perm_b32 v102, v70, v66, s97
    v_perm_b32 v103, v78, v74, s97
    v_perm_b32 v104, v55, v51, s96
    v_perm_b32 v105, v63, v59, s96
    v_perm_b32 v106, v71, v67, s96
    v_perm_b32 v107, v79, v75, s96
    v_perm_b32 v108, v55, v51, s97
    v_perm_b32 v109, v63, v59, s97
    v_perm_b32 v110, v71, v67, s97
    v_perm_b32 v111, v79, v75, s97
    v_mfma_f32_16x16x32_bf16 v[48:51], v[112:115], v[80:83], 0
    v_mfma_f32_16x16x32_bf16 v[52:55], v[112:115], v[84:87], 0
    v_mfma_f32_16x16x32_bf16 v[56:59], v[112:115], v[88:91], 0
    v_mfma_f32_16x16x32_bf16 v[60:63], v[112:115], v[92:95], 0
    v_mfma_f32_16x16x32_bf16 v[64:67], v[112:115], v[96:99], 0
    v_mfma_f32_16x16x32_bf16 v[68:71], v[112:115], v[100:103], 0
    v_mfma_f32_16x16x32_bf16 v[72:75], v[112:115], v[104:107], 0
    v_mfma_f32_16x16x32_bf16 v[76:79], v[112:115], v[108:111], 0
    s_nop 0
    v_add_f32_dpp v116, v49, v48 row_ror:8 row_mask:0x1 bank_mask:0x3
    v_add_f32_dpp v118, v53, v52 row_ror:8 row_mask:0x1 bank_mask:0x3
    v_add_f32_dpp v14, v50, v51 row_ror:8 row_mask:0x1 bank_mask:0xc
    v_add_f32_dpp v15, v54, v55 row_ror:8 row_mask:0x1 bank_mask:0xc
    v_add_f32_dpp v116, v57, v56 row_ror:8 row_mask:0x2 bank_mask:0x3
    v_add_f32_dpp v118, v61, v60 row_ror:8 row_mask:0x2 bank_mask:0x3
    v_add_f32_dpp v14, v58, v59 row_ror:8 row_mask:0x2 bank_mask:0xc
    v_add_f32_dpp v15, v62, v63 row_ror:8 row_mask:0x2 bank_mask:0xc
    v_add_f32_dpp v116, v65, v64 row_ror:8 row_mask:0x4 bank_mask:0x3
    v_add_f32_dpp v118, v69, v68 row_ror:8 row_mask:0x4 bank_mask:0x3
    v_add_f32_dpp v14, v66, v67 row_ror:8 row_mask:0x4 bank_mask:0xc
    v_add_f32_dpp v15, v70, v71 row_ror:8 row_mask:0x4 bank_mask:0xc
    v_add_f32_dpp v116, v73, v72 row_ror:8 row_mask:0x8 bank_mask:0x3
    v_add_f32_dpp v118, v77, v76 row_ror:8 row_mask:0x8 bank_mask:0x3
    v_add_f32_dpp v14, v74, v75 row_ror:8 row_mask:0x8 bank_mask:0xc
    v_add_f32_dpp v15, v78, v79 row_ror:8 row_mask:0x8 bank_mask:0xc
    s_nop 0
    v_mov_b32_dpp v116, v14 quad_perm:[0,1,2,3] row_mask:0xf bank_mask:0xc
    v_mov_b32_dpp v118, v15 quad_perm:[0,1,2,3] row_mask:0xf bank_mask:0xc
    v_mov_b32 v117, v118
    ds_write_b64 v12, v[116:117]
    s_waitcnt lgkmcnt(0)
    s_add_u32 s48, s48, 1
    s_mov_b32 s63, 1
    s_lshl_b32 s54, s24, 2
    s_add_u32 s54, s54, 142592
    v_mov_b32 v12, s54
    v_mov_b32 v13, 1
    s_mov_b64 exec, 1
    ds_write_b32 v12, v13
    s_mov_b64 exec, -1
    s_cmp_lg_u32 s3, 8
    s_cbranch_scc1 L_if_27
    v_min_u32 v12, 6, v1
    v_lshlrev_b32 v12, 2, v12
    v_add_u32 v12, 142592, v12
    s_mov_b32 s57, 1000000
L_flg_28:
    ds_read_b32 v13, v12
    s_waitcnt lgkmcnt(0)
    v_cmp_ne_u32 vcc, 1, v13
    s_nop 0
    s_cbranch_vccz L_flgd_29
    s_sub_u32 s57, s57, 1
    s_cmp_lg_u32 s57, 0
    s_cbranch_scc1 L_flg_28
L_flgd_29:
    v_lshlrev_b32 v13, 3, v1
    v_add_u32 v12, 138496, v13
    ds_read_b64 v[80:81], v12 offset:0
    ds_read_b64 v[82:83], v12 offset:512
    ds_read_b64 v[84:85], v12 offset:1024
    ds_read_b64 v[86:87], v12 offset:1536
    ds_read_b64 v[88:89], v12 offset:2048
    ds_read_b64 v[90:91], v12 offset:2560
    ds_read_b64 v[92:93], v12 offset:3072
    s_waitcnt lgkmcnt(0)
    v_add_f32 v80, v80, v82
    v_add_f32 v81, v81, v83
    v_add_f32 v84, v84, v86
    v_add_f32 v85, v85, v87
    v_add_f32 v88, v88, v90
    v_add_f32 v89, v89, v91
    v_add_f32 v80, v80, v84
    v_add_f32 v81, v81, v85
    v_add_f32 v88, v88, v92
    v_add_f32 v89, v89, v93
    v_add_f32 v80, v80, v88
    v_add_f32 v81, v81, v89
    v_cvt_pk_bf16_f32 v116, v80, v81
    v_mov_b32 v117, s48
    buffer_store_dwordx2 v[116:117], v13, s[36:39], s59 offen sc1
L_if_27:
    s_mov_b32 s28, s8
    s_mov_b32 s29, s9
    s_branch L_B_v2
L_B_nod:
    v_lshrrev_b32 v7, 5, v1
    v_and_b32 v8, 31, v1
    v_lshlrev_b32 v9, 1, v7
    v_xor_b32 v8, v8, v9
    v_lshlrev_b32 v8, 4, v8
    v_lshl_add_u32 v3, v7, 9, v8
    s_and_b32 s54, s95, 3
    s_lshl_b32 s54, s54, 6
    v_xor_b32 v3, s54, v3
    v_xor_b32 v4, 64, v3
    v_xor_b32 v5, 0x80, v3
    v_xor_b32 v6, 0xc0, v3
    s_and_b32 s100, s3, 7
    s_lshl_b32 s100, s100, 14
    s_lshl_b32 s54, s95, 10
    s_xor_b32 s100, s100, s54
    s_xor_b32 s101, s53, s54
    s_mov_b32 s30, 0x10000000
    s_mov_b32 s31, 0x20000
    s_waitcnt lgkmcnt(0)
    s_mov_b32 s28, s8
    s_mov_b32 s29, s9
    s_barrier
    s_load_dword s48, s[26:27], 0
    s_mov_b32 s25, 0
    s_branch L_B_v2
L_B_light:
    s_barrier
    v_lshrrev_b32 v7, 5, v1
    v_and_b32 v8, 31, v1
    v_lshlrev_b32 v9, 1, v7
    v_xor_b32 v8, v8, v9
    v_lshlrev_b32 v8, 4, v8
    v_lshl_add_u32 v3, v7, 9, v8
    s_and_b32 s54, s95, 3
    s_lshl_b32 s54, s54, 6
    v_xor_b32 v3, s54, v3
    v_xor_b32 v4, 64, v3
    v_xor_b32 v5, 0x80, v3
    v_xor_b32 v6, 0xc0, v3
    s_and_b32 s100, s3, 7
    s_lshl_b32 s100, s100, 14
    s_lshl_b32 s54, s95, 10
    s_xor_b32 s100, s100, s54
    s_xor_b32 s101, s53, s54
    s_mov_b32 s30, 0x10000000
    s_mov_b32 s31, 0x20000
    s_waitcnt lgkmcnt(0)
    s_mov_b32 s28, s8
    s_mov_b32 s29, s9
L_B_v2:
    s_setprio 1
    s_xor_b32 m0, s100, 0
    s_xor_b32 s54, s101, 0
    buffer_load_dwordx4 v3, s[28:31], s54 offen nt lds
    s_xor_b32 m0, s100, 1024
    s_xor_b32 s54, s101, 1024
    buffer_load_dwordx4 v4, s[28:31], s54 offen nt lds
    s_cmp_lt_u32 s51, 2
    s_cbranch_scc1 L_if_30
    s_load_dword s48, s[26:27], 0
    s_mov_b32 s25, 0
L_if_30:
    s_and_b32 s49, s2, 7
    s_lshr_b32 s50, s2, 3
    v_lshlrev_b32 v126, 4, v1
    s_mov_b32 s51, 0
    s_lshl_b32 s52, s49, 3
    s_add_u32 s52, s52, s50
    s_cmp_lt_u32 s50, 8
    s_cbranch_scc1 L_rd_31
    s_mov_b32 s51, 3
    s_sub_u32 s52, s52, 8
    s_cmp_lt_u32 s50, 16
    s_cbranch_scc1 L_rd_31
    s_sub_u32 s52, s50, 16
    s_lshl_b32 s52, s52, 3
    s_add_u32 s52, s52, s49
    s_mov_b32 s51, 1
    s_cmp_lt_u32 s52, 56
    s_cbranch_scc1 L_rd_31
    s_mov_b32 s51, 2
    s_sub_u32 s52, s52, 56
    s_cmp_lt_u32 s52, 28
    s_cbranch_scc1 L_rd_31
    s_mov_b32 s51, 4
    s_sub_u32 s52, s52, 28
    s_cmp_lt_u32 s52, 28
    s_cbranch_scc1 L_rd_31
    s_mov_b32 s51, 5
L_rd_31:
    s_xor_b32 m0, s100, 2048
    s_xor_b32 s54, s101, 2048
    buffer_load_dwordx4 v5, s[28:31], s54 offen nt lds
    s_xor_b32 m0, s100, 3072
    s_xor_b32 s54, s101, 3072
    buffer_load_dwordx4 v6, s[28:31], s54 offen nt lds
    s_and_b32 s49, s2, 7
    s_lshr_b32 s50, s2, 3
    v_lshlrev_b32 v126, 4, v1
    s_getpc_b64 s[98:99]
L_pc_32:
    s_sub_u32 s98, s98, L_pc_32-L_kstart
    s_subb_u32 s99, s99, 0
    s_lshl_b32 s54, s3, 10
    v_add_u32 v11, s54, v126
    v_min_u32 v11, L_exit-L_kstart-16, v11
    global_load_dwordx4 v[48:51], v11, s[98:99]
    s_cmpk_lt_u32 s51, 4
    s_cbranch_scc1 L_thr_33
    s_waitcnt vmcnt(1)
L_thr_33:
    s_xor_b32 m0, s100, 4096
    s_xor_b32 s54, s101, 4096
    buffer_load_dwordx4 v3, s[28:31], s54 offen nt lds
    s_cmpk_lt_u32 s51, 4
    s_cbranch_scc1 L_thr_34
    s_waitcnt vmcnt(1)
L_thr_34:
    s_xor_b32 m0, s100, 5120
    s_xor_b32 s54, s101, 5120
    buffer_load_dwordx4 v4, s[28:31], s54 offen nt lds
    s_cmpk_lt_u32 s51, 4
    s_cbranch_scc1 L_thr_35
    s_waitcnt vmcnt(1)
L_thr_35:
    s_xor_b32 m0, s100, 6144
    s_xor_b32 s54, s101, 6144
    buffer_load_dwordx4 v5, s[28:31], s54 offen nt lds
    s_cmpk_lt_u32 s51, 4
    s_cbranch_scc1 L_thr_36
    s_waitcnt vmcnt(1)
L_thr_36:
    s_xor_b32 m0, s100, 7168
    s_xor_b32 s54, s101, 7168
    buffer_load_dwordx4 v6, s[28:31], s54 offen nt lds
    s_cmpk_lt_u32 s51, 4
    s_cbranch_scc1 L_thr_37
    s_waitcnt vmcnt(1)
L_thr_37:
    s_xor_b32 m0, s100, 8192
    s_xor_b32 s54, s101, 8192
    buffer_load_dwordx4 v3, s[28:31], s54 offen nt lds
    s_cmpk_lt_u32 s51, 4
    s_cbranch_scc1 L_thr_38
    s_waitcnt vmcnt(1)
L_thr_38:
    s_xor_b32 m0, s100, 9216
    s_xor_b32 s54, s101, 9216
    buffer_load_dwordx4 v4, s[28:31], s54 offen nt lds
    s_cmpk_lt_u32 s51, 4
    s_cbranch_scc1 L_thr_39
    s_waitcnt vmcnt(1)
L_thr_39:
    s_xor_b32 m0, s100, 10240
    s_xor_b32 s54, s101, 10240
    buffer_load_dwordx4 v5, s[28:31], s54 offen nt lds
    s_cmpk_lt_u32 s51, 4
    s_cbranch_scc1 L_thr_40
    s_waitcnt vmcnt(1)
L_thr_40:
    s_xor_b32 m0, s100, 11264
    s_xor_b32 s54, s101, 11264
    buffer_load_dwordx4 v6, s[28:31], s54 offen nt lds
    s_cmpk_lt_u32 s51, 4
    s_cbranch_scc1 L_thr_41
    s_waitcnt vmcnt(1)
L_thr_41:
    s_xor_b32 m0, s100, 12288
    s_xor_b32 s54, s101, 12288
    buffer_load_dwordx4 v3, s[28:31], s54 offen nt lds
    s_cmpk_lt_u32 s51, 4
    s_cbranch_scc1 L_thr_42
    s_waitcnt vmcnt(1)
L_thr_42:
    s_xor_b32 m0, s100, 13312
    s_xor_b32 s54, s101, 13312
    buffer_load_dwordx4 v4, s[28:31], s54 offen nt lds
    s_cmpk_lt_u32 s51, 4
    s_cbranch_scc1 L_thr_43
    s_waitcnt vmcnt(1)
L_thr_43:
    s_xor_b32 m0, s100, 14336
    s_xor_b32 s54, s101, 14336
    buffer_load_dwordx4 v5, s[28:31], s54 offen nt lds
    s_cmpk_lt_u32 s51, 4
    s_cbranch_scc1 L_thr_44
    s_waitcnt vmcnt(1)
L_thr_44:
    s_xor_b32 m0, s100, 15360
    s_xor_b32 s54, s101, 15360
    buffer_load_dwordx4 v6, s[28:31], s54 offen nt lds
    s_mov_b32 s36, s26
    s_mov_b32 s37, s27
    s_mov_b32 s38, 0x40000000
    s_mov_b32 s39, 0x20000
    s_mov_b32 s51, 0
    s_lshl_b32 s52, s49, 3
    s_add_u32 s52, s52, s50
    s_cmp_lt_u32 s50, 8
    s_cbranch_scc1 L_rd_45
    s_mov_b32 s51, 3
    s_sub_u32 s52, s52, 8
    s_cmp_lt_u32 s50, 16
    s_cbranch_scc1 L_rd_45
    s_sub_u32 s52, s50, 16
    s_lshl_b32 s52, s52, 3
    s_add_u32 s52, s52, s49
    s_mov_b32 s51, 1
    s_cmp_lt_u32 s52, 56
    s_cbranch_scc1 L_rd_45
    s_mov_b32 s51, 2
    s_sub_u32 s52, s52, 56
    s_cmp_lt_u32 s52, 28
    s_cbranch_scc1 L_rd_45
    s_mov_b32 s51, 4
    s_sub_u32 s52, s52, 28
    s_cmp_lt_u32 s52, 28
    s_cbranch_scc1 L_rd_45
    s_mov_b32 s51, 5
L_rd_45:
    s_cmp_eq_u32 s63, 1
    s_cbranch_scc1 L_tg_46
    s_waitcnt lgkmcnt(0)
    s_add_u32 s48, s48, 1
L_tg_46:
    s_cmp_lg_u32 s51, 2
    s_cbranch_scc1 L_if_48
    s_mov_b32 s32, s20
    s_mov_b32 s33, s21
    s_mov_b32 s34, 0x188000
    s_mov_b32 s35, 0x20000
    s_sub_u32 s24, s3, 8
    s_mov_b32 s58, 896
    s_mul_i32 s60, s52, 57344
    s_lshl_b32 s54, s24, 7
    s_add_u32 s60, s60, s54
    v_lshrrev_b32 v11, 3, v1
    v_and_b32 v10, 7, v1
    v_lshlrev_b32 v10, 4, v10
    s_lshl_b32 s54, s58, 3
    v_mul_u32_u24 v11, s54, v11
    v_add_u32 v10, v10, v11
    v_bfe_u32 v7, v1, 1, 1
    v_lshlrev_b32 v7, 7, v7
    v_lshrrev_b32 v11, 4, v1
    v_lshl_add_u32 v7, v11, 5, v7
    v_and_b32 v11, 1, v1
    v_lshl_add_u32 v7, v11, 4, v7
    v_add_u32 v7, 133376, v7
    v_bfe_u32 v8, v1, 1, 2
    v_mul_u32_u24 v8, 7168, v8
    v_bfe_u32 v11, v1, 3, 1
    v_lshl_add_u32 v8, v11, 7, v8
    v_and_b32 v11, 1, v1
    v_lshl_add_u32 v8, v11, 6, v8
    v_lshrrev_b32 v11, 4, v1
    v_lshl_add_u32 v8, v11, 4, v8
    s_mul_i32 s54, s24, 28672
    s_lshl_b32 s101, s52, 8
    s_add_u32 s101, s101, s54
    s_add_u32 s101, s101, 73728
    s_branch L_rp_47
L_if_48:
    s_cmp_lg_u32 s51, 3
    s_cbranch_scc1 L_if_49
    s_mov_b32 s32, s12
    s_mov_b32 s33, s13
    s_mov_b32 s34, 0x380000
    s_mov_b32 s35, 0x20000
    s_sub_u32 s24, s3, 8
    s_mov_b32 s58, 896
    s_mul_i32 s60, s52, 57344
    s_lshl_b32 s54, s24, 7
    s_add_u32 s60, s60, s54
    v_lshrrev_b32 v11, 3, v1
    v_and_b32 v10, 7, v1
    v_lshlrev_b32 v10, 4, v10
    s_lshl_b32 s54, s58, 3
    v_mul_u32_u24 v11, s54, v11
    v_add_u32 v10, v10, v11
    v_bfe_u32 v12, v1, 1, 1
    v_lshlrev_b32 v12, 7, v12
    v_lshrrev_b32 v11, 4, v1
    v_lshl_add_u32 v12, v11, 5, v12
    v_and_b32 v11, 1, v1
    v_lshl_add_u32 v12, v11, 4, v12
    v_add_u32 v12, 133888, v12
    v_bfe_u32 v13, v1, 1, 2
    v_mul_u32_u24 v13, 16384, v13
    v_bfe_u32 v11, v1, 3, 1
    v_lshl_add_u32 v13, v11, 7, v13
    v_and_b32 v11, 1, v1
    v_lshl_add_u32 v13, v11, 6, v13
    v_lshrrev_b32 v11, 4, v1
    v_lshl_add_u32 v13, v11, 4, v13
    s_mul_i32 s54, s24, 65536
    s_lshl_b32 s14, s52, 8
    s_add_u32 s14, s14, s54
    s_add_u32 s14, s14, 274432
    v_and_b32 v14, 15, v1
    v_lshrrev_b32 v15, 4, v1
    v_lshlrev_b32 v11, 4, v15
    v_lshl_add_u32 v7, v14, 9, v11
    s_and_b32 s56, s3, 1
    s_lshr_b32 s59, s3, 1
    s_lshl_b32 s100, s52, 14
    s_lshl_b32 s54, s56, 13
    s_add_u32 s100, s100, s54
    s_lshl_b32 s54, s59, 6
    s_add_u32 s100, s100, s54
    s_add_u32 s100, s100, 1048576
    s_lshl_b32 s54, s56, 7
    s_lshl_b32 s55, s59, 4
    s_add_u32 s54, s54, s55
    s_add_u32 s54, s54, 133888
    v_lshl_add_u32 v9, v15, 2, s54
    s_branch L_rp_47
L_if_49:
    s_cmp_lg_u32 s51, 4
    s_cbranch_scc1 L_if_50
    s_mov_b32 s40, s4
    s_mov_b32 s41, s5
    s_mov_b32 s42, 0x700
    s_mov_b32 s43, 0x20000
    s_mov_b32 s44, s22
    s_mov_b32 s45, s23
    s_mov_b32 s46, 0x700
    s_mov_b32 s47, 0x20000
    v_bfe_u32 v7, v1, 4, 1
    v_mul_u32_u24 v7, 896, v7
    v_and_b32 v11, 15, v1
    v_lshl_add_u32 v7, v11, 1, v7
    s_lshl_b32 s54, s52, 5
    v_add_u32 v7, s54, v7
    s_lshl_b32 s54, s3, 7
    s_add_u32 s54, s54, 134400
    v_lshl_add_u32 v8, v1, 3, s54
    v_and_b32 v11, 31, v1
    v_lshlrev_b32 v11, 2, v11
    v_lshrrev_b32 v14, 5, v1
    v_lshl_add_u32 v9, v14, 9, v11
    v_add_u32 v9, 134400, v9
    s_mul_i32 s100, s52, 7168
    s_lshl_b32 s54, s3, 10
    s_add_u32 s100, s100, s54
    s_add_u32 s100, s100, 73728
    s_lshl_b32 s101, s52, 14
    s_lshl_b32 s54, s3, 11
    s_add_u32 s101, s101, s54
    s_add_u32 s101, s101, 274432
L_if_50:
L_rp_47:
    s_sub_u32 s54, s51, 2
    s_cmp_ge_u32 s54, 2
    s_cbranch_scc1 L_nld_51
    s_cmp_eq_u32 s3, 15
    s_cbranch_scc1 L_nld_51
    s_setprio 0
    s_mov_b32 s54, s60
    buffer_load_dwordx4 v[48:51], v10, s[32:35], s54 offen nt
    s_add_u32 s54, s54, s58
    buffer_load_dwordx4 v[52:55], v10, s[32:35], s54 offen nt
    s_add_u32 s54, s54, s58
    buffer_load_dwordx4 v[56:59], v10, s[32:35], s54 offen nt
    s_add_u32 s54, s54, s58
    buffer_load_dwordx4 v[60:63], v10, s[32:35], s54 offen nt
    s_add_u32 s54, s54, s58
    buffer_load_dwordx4 v[64:67], v10, s[32:35], s54 offen nt
    s_add_u32 s54, s54, s58
    buffer_load_dwordx4 v[68:71], v10, s[32:35], s54 offen nt
    s_add_u32 s54, s54, s58
    buffer_load_dwordx4 v[72:75], v10, s[32:35], s54 offen nt
    s_add_u32 s54, s54, s58
    buffer_load_dwordx4 v[76:79], v10, s[32:35], s54 offen nt
    s_mov_b32 s25, 8
L_nld_51:
    v_lshrrev_b32 v15, 4, v1
    v_and_b32 v14, 1, v1
    v_lshlrev_b32 v14, 9, v14
    v_lshl_add_u32 v14, v15, 4, v14
    v_add_u32 v123, 132096, v14
    v_and_b32 v11, 15, v1
    v_lshlrev_b32 v14, 3, v11
    v_lshl_add_u32 v122, v15, 16, v14
    v_and_b32 v11, 7, v1
    v_lshlrev_b32 v11, 3, v11
    v_and_b32 v15, 1, v15
    v_lshl_add_u32 v11, v15, 2, v11
    v_add_u32 v124, 133120, v11
    v_lshrrev_b32 v11, 2, v1
    v_and_b32 v15, 7, v11
    v_xor_b32 v15, s3, v15
    v_lshlrev_b32 v15, 5, v15
    v_lshl_add_u32 v11, v11, 9, v15
    v_and_b32 v14, 3, v1
    v_lshl_add_u32 v120, v14, 3, v11
    v_add_u32 v121, 0x10000, v120
    s_lshl_b32 s54, s49, 3
    s_lshr_b32 s55, s3, 2
    s_add_u32 s54, s54, s55
    s_lshl_b32 s54, s54, 14
    s_and_b32 s55, s50, 1
    s_lshl_b32 s55, s55, 13
    s_add_u32 s54, s54, s55
    s_lshr_b32 s55, s50, 1
    s_lshl_b32 s55, s55, 9
    s_add_u32 s54, s54, s55
    s_and_b32 s55, s3, 3
    s_lshl_b32 s55, s55, 7
    s_add_u32 s54, s54, s55
    s_add_u32 s61, s54, 1048576
L_JOIN:
    v_mov_b32 v11, 142632
    s_mov_b32 s57, 1000000
L_sw_52:
    ds_read_b32 v14, v11
    s_waitcnt lgkmcnt(0)
    v_cmp_gt_u32 vcc, 8, v14
    s_nop 0
    s_cbranch_vccz L_swd_53
    s_sub_u32 s57, s57, 1
    s_cmp_lg_u32 s57, 0
    s_cbranch_scc1 L_sw_52
L_swd_53:
    ds_read_b128 v[16:19], v123 offset:0
    ds_read_b128 v[20:23], v123 offset:64
    ds_read_b128 v[24:27], v123 offset:128
    ds_read_b128 v[28:31], v123 offset:192
    ds_read_b128 v[32:35], v123 offset:256
    ds_read_b128 v[36:39], v123 offset:320
    ds_read_b128 v[40:43], v123 offset:384
    ds_read_b128 v[44:47], v123 offset:448
    ds_read_b32 v116, v124
    ds_read_b32 v118, v124 offset:128
    v_mov_b32 v11, 142636
    ds_read_b32 v14, v11
    v_mov_b32 v119, s48
    s_waitcnt lgkmcnt(0)
    v_readfirstlane_b32 s63, v14
    v_max_f32_dpp v116, v116, v116 row_ror:4 row_mask:0xf bank_mask:0xf
    v_add_f32_dpp v118, v118, v118 row_ror:4 row_mask:0xf bank_mask:0xf
    s_nop 0
    v_max_f32_dpp v116, v116, v116 row_ror:2 row_mask:0xf bank_mask:0xf
    v_add_f32_dpp v118, v118, v118 row_ror:2 row_mask:0xf bank_mask:0xf
    s_nop 0
    v_max_f32_dpp v116, v116, v116 row_ror:1 row_mask:0xf bank_mask:0xf
    v_add_f32_dpp v118, v118, v118 row_ror:1 row_mask:0xf bank_mask:0xf
    s_mov_b32 s98, 0xcccccccc
    s_mov_b32 s99, 0xcccccccc
    v_cndmask_b32 v118, v116, v118, s[98:99]
    s_sub_u32 s54, s3, 8
    s_cmp_ge_u32 s54, 4
    s_cbranch_scc1 L_cv_54
    s_cmp_eq_u32 s25, 8
    s_cbranch_scc1 L_vw_55
    s_waitcnt vmcnt(0)
    s_branch L_vw_56
L_vw_55:
    s_waitcnt vmcnt(8)
L_vw_56:
    s_waitcnt lgkmcnt(0)
    v_mov_b32 v11, 142640
    v_mov_b32 v14, 1
    s_mov_b64 exec, 1
    ds_add_u32 v11, v14
    s_mov_b64 exec, -1
L_cv_54:
    v_mov_b32 v11, 142640
    s_mov_b32 s57, 1000000
L_sw_57:
    ds_read_b32 v14, v11
    s_waitcnt lgkmcnt(0)
    v_cmp_gt_u32 vcc, 4, v14
    s_nop 0
    s_cbranch_vccz L_swd_58
    s_sub_u32 s57, s57, 1
    s_cmp_lg_u32 s57, 0
    s_cbranch_scc1 L_sw_57
L_swd_58:
    ds_read_b64_tr_b16 v[80:81], v120 offset:0
    ds_read_b64_tr_b16 v[82:83], v120 offset:8192
    ds_read_b64_tr_b16 v[84:85], v120 offset:16384
    ds_read_b64_tr_b16 v[86:87], v120 offset:24576
    ds_read_b64_tr_b16 v[88:89], v120 offset:32768
    ds_read_b64_tr_b16 v[90:91], v120 offset:40960
    ds_read_b64_tr_b16 v[92:93], v120 offset:49152
    ds_read_b64_tr_b16 v[94:95], v120 offset:57344
    s_waitcnt lgkmcnt(6)
    v_mfma_f32_16x16x32_bf16 v[112:115], v[16:19], v[80:83], 0
    s_waitcnt lgkmcnt(4)
    v_mfma_f32_16x16x32_bf16 v[112:115], v[20:23], v[84:87], v[112:115]
    s_waitcnt lgkmcnt(2)
    v_mfma_f32_16x16x32_bf16 v[112:115], v[24:27], v[88:91], v[112:115]
    s_waitcnt lgkmcnt(0)
    v_mfma_f32_16x16x32_bf16 v[112:115], v[28:31], v[92:95], v[112:115]
    s_cmp_eq_u32 s25, 8
    s_cbranch_scc1 L_vw_59
    s_waitcnt vmcnt(0)
    s_branch L_vw_60
L_vw_59:
    s_waitcnt vmcnt(8)
L_vw_60:
    s_barrier
    ds_read_b64_tr_b16 v[96:97], v121 offset:0
    ds_read_b64_tr_b16 v[98:99], v121 offset:8192
    ds_read_b64_tr_b16 v[100:101], v121 offset:16384
    ds_read_b64_tr_b16 v[102:103], v121 offset:24576
    ds_read_b64_tr_b16 v[104:105], v121 offset:32768
    ds_read_b64_tr_b16 v[106:107], v121 offset:40960
    ds_read_b64_tr_b16 v[108:109], v121 offset:49152
    ds_read_b64_tr_b16 v[110:111], v121 offset:57344
    s_waitcnt lgkmcnt(6)
    v_mfma_f32_16x16x32_bf16 v[112:115], v[32:35], v[96:99], v[112:115]
    s_waitcnt lgkmcnt(4)
    v_mfma_f32_16x16x32_bf16 v[112:115], v[36:39], v[100:103], v[112:115]
    s_waitcnt lgkmcnt(2)
    v_mfma_f32_16x16x32_bf16 v[112:115], v[40:43], v[104:107], v[112:115]
    s_waitcnt lgkmcnt(0)
    v_mfma_f32_16x16x32_bf16 v[112:115], v[44:47], v[108:111], v[112:115]
    s_nop 7
    v_permlane16_swap_b32 v112, v113
    v_mov_b32 v116, v112
    s_nop 0
    v_mov_b32_dpp v117, v112 quad_perm:[1,0,3,2] row_mask:0xf bank_mask:0xf
    s_mov_b32 exec_lo, 0x55555555
    s_mov_b32 exec_hi, 0
    s_cmp_eq_u32 s63, 1
    s_cbranch_scc1 L_loc_61
    buffer_store_dwordx4 v[116:119], v122, s[36:39], s61 offen sc1
    s_branch L_loc_62
L_loc_61:
    buffer_store_dwordx4 v[116:119], v122, s[36:39], s61 offen
L_loc_62:
    s_mov_b64 exec, -1
    s_cmp_eq_u32 s51, 3
    s_cbranch_scc1 L_T_WO
    s_cmp_eq_u32 s51, 4
    s_cbranch_scc1 L_T_R
    s_cmp_eq_u32 s51, 2
    s_cbranch_scc1 L_T_D
    s_branch L_FIN
L_T_D:
    s_sub_u32 s54, s3, 8
    s_cmp_ge_u32 s54, 7
    s_cbranch_scc1 L_dw_63
    ds_read_b128 v[80:83], v7
    ds_read_b128 v[84:87], v7 offset:256
    s_waitcnt lgkmcnt(0)
    v_lshlrev_b32 v88, 16, v80
    v_and_b32 v89, 0xffff0000, v80
    v_lshlrev_b32 v96, 16, v84
    v_and_b32 v97, 0xffff0000, v84
    v_lshlrev_b32 v90, 16, v81
    v_and_b32 v91, 0xffff0000, v81
    v_lshlrev_b32 v98, 16, v85
    v_and_b32 v99, 0xffff0000, v85
    v_lshlrev_b32 v92, 16, v82
    v_and_b32 v93, 0xffff0000, v82
    v_lshlrev_b32 v100, 16, v86
    v_and_b32 v101, 0xffff0000, v86
    v_lshlrev_b32 v94, 16, v83
    v_and_b32 v95, 0xffff0000, v83
    v_lshlrev_b32 v102, 16, v87
    v_and_b32 v103, 0xffff0000, v87
    v_mul_f32 v88, v88, v96
    v_mul_f32 v89, v89, v97
    v_mul_f32 v90, v90, v98
    v_mul_f32 v91, v91, v99
    v_mul_f32 v92, v92, v100
    v_mul_f32 v93, v93, v101
    v_mul_f32 v94, v94, v102
    v_mul_f32 v95, v95, v103
    v_cvt_pk_bf16_f32 v112, v88, v89
    v_cvt_pk_bf16_f32 v113, v90, v91
    v_cvt_pk_bf16_f32 v114, v92, v93
    v_cvt_pk_bf16_f32 v115, v94, v95
    v_mov_b32 v117, s48
    v_mov_b32 v119, s48
    s_waitcnt vmcnt(0)
    s_mov_b32 s96, 0x05040100
    s_mov_b32 s97, 0x07060302
    v_perm_b32 v16, v52, v48, s96
    v_perm_b32 v17, v60, v56, s96
    v_perm_b32 v18, v68, v64, s96
    v_perm_b32 v19, v76, v72, s96
    v_perm_b32 v20, v52, v48, s97
    v_perm_b32 v21, v60, v56, s97
    v_perm_b32 v22, v68, v64, s97
    v_perm_b32 v23, v76, v72, s97
    v_perm_b32 v24, v53, v49, s96
    v_perm_b32 v25, v61, v57, s96
    v_perm_b32 v26, v69, v65, s96
    v_perm_b32 v27, v77, v73, s96
    v_perm_b32 v28, v53, v49, s97
    v_perm_b32 v29, v61, v57, s97
    v_perm_b32 v30, v69, v65, s97
    v_perm_b32 v31, v77, v73, s97
    v_perm_b32 v32, v54, v50, s96
    v_perm_b32 v33, v62, v58, s96
    v_perm_b32 v34, v70, v66, s96
    v_perm_b32 v35, v78, v74, s96
    v_perm_b32 v36, v54, v50, s97
    v_perm_b32 v37, v62, v58, s97
    v_perm_b32 v38, v70, v66, s97
    v_perm_b32 v39, v78, v74, s97
    v_perm_b32 v40, v55, v51, s96
    v_perm_b32 v41, v63, v59, s96
    v_perm_b32 v42, v71, v67, s96
    v_perm_b32 v43, v79, v75, s96
    v_perm_b32 v44, v55, v51, s97
    v_perm_b32 v45, v63, v59, s97
    v_perm_b32 v46, v71, v67, s97
    v_perm_b32 v47, v79, v75, s97
    v_mfma_f32_16x16x32_bf16 v[48:51], v[112:115], v[16:19], 0
    v_mfma_f32_16x16x32_bf16 v[52:55], v[112:115], v[20:23], 0
    v_mfma_f32_16x16x32_bf16 v[56:59], v[112:115], v[24:27], 0
    v_mfma_f32_16x16x32_bf16 v[60:63], v[112:115], v[28:31], 0
    v_mfma_f32_16x16x32_bf16 v[64:67], v[112:115], v[32:35], 0
    v_mfma_f32_16x16x32_bf16 v[68:71], v[112:115], v[36:39], 0
    v_mfma_f32_16x16x32_bf16 v[72:75], v[112:115], v[40:43], 0
    v_mfma_f32_16x16x32_bf16 v[76:79], v[112:115], v[44:47], 0
    s_nop 0
    v_add_f32_dpp v116, v49, v48 row_ror:8 row_mask:0x1 bank_mask:0x3
    v_add_f32_dpp v118, v53, v52 row_ror:8 row_mask:0x1 bank_mask:0x3
    v_add_f32_dpp v14, v50, v51 row_ror:8 row_mask:0x1 bank_mask:0xc
    v_add_f32_dpp v15, v54, v55 row_ror:8 row_mask:0x1 bank_mask:0xc
    v_add_f32_dpp v116, v57, v56 row_ror:8 row_mask:0x2 bank_mask:0x3
    v_add_f32_dpp v118, v61, v60 row_ror:8 row_mask:0x2 bank_mask:0x3
    v_add_f32_dpp v14, v58, v59 row_ror:8 row_mask:0x2 bank_mask:0xc
    v_add_f32_dpp v15, v62, v63 row_ror:8 row_mask:0x2 bank_mask:0xc
    v_add_f32_dpp v116, v65, v64 row_ror:8 row_mask:0x4 bank_mask:0x3
    v_add_f32_dpp v118, v69, v68 row_ror:8 row_mask:0x4 bank_mask:0x3
    v_add_f32_dpp v14, v66, v67 row_ror:8 row_mask:0x4 bank_mask:0xc
    v_add_f32_dpp v15, v70, v71 row_ror:8 row_mask:0x4 bank_mask:0xc
    v_add_f32_dpp v116, v73, v72 row_ror:8 row_mask:0x8 bank_mask:0x3
    v_add_f32_dpp v118, v77, v76 row_ror:8 row_mask:0x8 bank_mask:0x3
    v_add_f32_dpp v14, v74, v75 row_ror:8 row_mask:0x8 bank_mask:0xc
    v_add_f32_dpp v15, v78, v79 row_ror:8 row_mask:0x8 bank_mask:0xc
    s_nop 0
    v_mov_b32_dpp v116, v14 quad_perm:[0,1,2,3] row_mask:0xf bank_mask:0xc
    v_mov_b32_dpp v118, v15 quad_perm:[0,1,2,3] row_mask:0xf bank_mask:0xc
    buffer_store_dwordx4 v[116:119], v8, s[36:39], s101 offen sc1
L_dw_63:
    s_branch L_FIN
L_T_WO:
    s_cmp_ge_u32 s3, 8
    s_cbranch_scc1 L_T_WO_B
    buffer_load_dwordx4 v[80:83], v7, s[36:39], s100 offen sc1
    buffer_load_dwordx4 v[84:87], v7, s[36:39], s100 offen offset:256 sc1
    s_mov_b32 s57, 20000
    s_waitcnt vmcnt(0)
    s_branch L_mpc_66
L_mp_64:
    s_bcnt1_i32_b64 s56, exec
    s_cmp_le_u32 s56, 8
    s_cbranch_scc1 L_ad_67
    s_sleep 10
L_ad_67:
    s_sleep 1
    buffer_load_dwordx4 v[80:83], v7, s[36:39], s100 offen sc1
    buffer_load_dwordx4 v[84:87], v7, s[36:39], s100 offen offset:256 sc1
    s_waitcnt vmcnt(0)
L_mpc_66:
    v_cmp_ne_u32 vcc, s48, v83
    v_cmp_ne_u32 s[98:99], s48, v87
    s_nop 0
    s_or_b64 vcc, vcc, s[98:99]
    s_cbranch_scc0 L_mpd_65
    s_mov_b64 exec, vcc
    s_sub_u32 s57, s57, 1
    s_cmp_lg_u32 s57, 0
    s_cbranch_scc1 L_mp_64
L_mpd_65:
    s_mov_b64 exec, -1
    v_mov_b32 v88, v82
    v_mov_b32 v89, v82
    s_nop 1
    v_permlane16_swap_b32 v88, v89
    s_nop 1
    v_max_f32_dpp v90, v88, v88 row_ror:8 row_mask:0xf bank_mask:0xf
    s_nop 1
    v_max_f32_dpp v90, v90, v90 row_ror:4 row_mask:0xf bank_mask:0xf
    s_nop 1
    v_max_f32_dpp v90, v90, v90 row_ror:2 row_mask:0xf bank_mask:0xf
    s_nop 1
    v_max_f32_dpp v90, v90, v90 row_ror:1 row_mask:0xf bank_mask:0xf
    v_sub_f32 v91, v88, v90
    v_mul_f32 v91, 0x3db8aa3b, v91
    v_exp_f32 v91, v91
    s_nop 0
    v_mul_f32 v89, v89, v91
    v_mul_f32 v80, v80, v91
    v_mul_f32 v81, v81, v91
    v_mul_f32 v84, v84, v91
    v_mul_f32 v85, v85, v91
    v_add_f32_dpp v89, v89, v89 row_ror:8 row_mask:0xf bank_mask:0xf
    v_add_f32_dpp v80, v80, v80 row_ror:8 row_mask:0xf bank_mask:0xf
    v_add_f32_dpp v81, v81, v81 row_ror:8 row_mask:0xf bank_mask:0xf
    v_add_f32_dpp v84, v84, v84 row_ror:8 row_mask:0xf bank_mask:0xf
    v_add_f32_dpp v85, v85, v85 row_ror:8 row_mask:0xf bank_mask:0xf
    v_add_f32_dpp v89, v89, v89 row_ror:4 row_mask:0xf bank_mask:0xf
    v_add_f32_dpp v80, v80, v80 row_ror:4 row_mask:0xf bank_mask:0xf
    v_add_f32_dpp v81, v81, v81 row_ror:4 row_mask:0xf bank_mask:0xf
    v_add_f32_dpp v84, v84, v84 row_ror:4 row_mask:0xf bank_mask:0xf
    v_add_f32_dpp v85, v85, v85 row_ror:4 row_mask:0xf bank_mask:0xf
    v_add_f32_dpp v89, v89, v89 row_ror:2 row_mask:0xf bank_mask:0xf
    v_add_f32_dpp v80, v80, v80 row_ror:2 row_mask:0xf bank_mask:0xf
    v_add_f32_dpp v81, v81, v81 row_ror:2 row_mask:0xf bank_mask:0xf
    v_add_f32_dpp v84, v84, v84 row_ror:2 row_mask:0xf bank_mask:0xf
    v_add_f32_dpp v85, v85, v85 row_ror:2 row_mask:0xf bank_mask:0xf
    v_add_f32_dpp v89, v89, v89 row_ror:1 row_mask:0xf bank_mask:0xf
    v_add_f32_dpp v80, v80, v80 row_ror:1 row_mask:0xf bank_mask:0xf
    v_add_f32_dpp v81, v81, v81 row_ror:1 row_mask:0xf bank_mask:0xf
    v_add_f32_dpp v84, v84, v84 row_ror:1 row_mask:0xf bank_mask:0xf
    v_add_f32_dpp v85, v85, v85 row_ror:1 row_mask:0xf bank_mask:0xf
    v_rcp_f32 v89, v89
    s_nop 0
    v_mul_f32 v80, v80, v89
    v_mul_f32 v81, v81, v89
    v_mul_f32 v84, v84, v89
    v_mul_f32 v85, v85, v89
    v_cvt_pk_bf16_f32 v80, v80, v81
    v_cvt_pk_bf16_f32 v84, v84, v85
    s_mov_b32 exec_lo, 0x10001
    s_mov_b32 exec_hi, 0x10001
    ds_write_b32 v9, v80
    ds_write_b32 v9, v84 offset:64
    s_mov_b64 exec, -1
    s_waitcnt lgkmcnt(0)
    s_barrier
    s_branch L_FIN
L_T_WO_B:
    s_sub_u32 s54, s3, 8
    s_cmp_ge_u32 s54, 7
    s_cbranch_scc1 L_dw_68
    v_mov_b32 v117, s48
    v_mov_b32 v119, s48
    s_waitcnt vmcnt(0)
    s_mov_b32 s96, 0x05040100
    s_mov_b32 s97, 0x07060302
    v_perm_b32 v16, v52, v48, s96
    v_perm_b32 v17, v60, v56, s96
    v_perm_b32 v18, v68, v64, s96
    v_perm_b32 v19, v76, v72, s96
    v_perm_b32 v20, v52, v48, s97
    v_perm_b32 v21, v60, v56, s97
    v_perm_b32 v22, v68, v64, s97
    v_perm_b32 v23, v76, v72, s97
    v_perm_b32 v24, v53, v49, s96
    v_perm_b32 v25, v61, v57, s96
    v_perm_b32 v26, v69, v65, s96
    v_perm_b32 v27, v77, v73, s96
    v_perm_b32 v28, v53, v49, s97
    v_perm_b32 v29, v61, v57, s97
    v_perm_b32 v30, v69, v65, s97
    v_perm_b32 v31, v77, v73, s97
    v_perm_b32 v32, v54, v50, s96
    v_perm_b32 v33, v62, v58, s96
    v_perm_b32 v34, v70, v66, s96
    v_perm_b32 v35, v78, v74, s96
    v_perm_b32 v36, v54, v50, s97
    v_perm_b32 v37, v62, v58, s97
    v_perm_b32 v38, v70, v66, s97
    v_perm_b32 v39, v78, v74, s97
    v_perm_b32 v40, v55, v51, s96
    v_perm_b32 v41, v63, v59, s96
    v_perm_b32 v42, v71, v67, s96
    v_perm_b32 v43, v79, v75, s96
    v_perm_b32 v44, v55, v51, s97
    v_perm_b32 v45, v63, v59, s97
    v_perm_b32 v46, v71, v67, s97
    v_perm_b32 v47, v79, v75, s97
L_dw_68:
    s_barrier
    s_sub_u32 s54, s3, 8
    s_cmp_ge_u32 s54, 7
    s_cbranch_scc1 L_dw_69
    ds_read_b128 v[112:115], v12
    s_waitcnt lgkmcnt(0)
    v_mfma_f32_16x16x32_bf16 v[48:51], v[112:115], v[16:19], 0
    v_mfma_f32_16x16x32_bf16 v[52:55], v[112:115], v[20:23], 0
    v_mfma_f32_16x16x32_bf16 v[56:59], v[112:115], v[24:27], 0
    v_mfma_f32_16x16x32_bf16 v[60:63], v[112:115], v[28:31], 0
    v_mfma_f32_16x16x32_bf16 v[64:67], v[112:115], v[32:35], 0
    v_mfma_f32_16x16x32_bf16 v[68:71], v[112:115], v[36:39], 0
    v_mfma_f32_16x16x32_bf16 v[72:75], v[112:115], v[40:43], 0
    v_mfma_f32_16x16x32_bf16 v[76:79], v[112:115], v[44:47], 0
    s_nop 0
    v_add_f32_dpp v116, v49, v48 row_ror:8 row_mask:0x1 bank_mask:0x3
    v_add_f32_dpp v118, v53, v52 row_ror:8 row_mask:0x1 bank_mask:0x3
    v_add_f32_dpp v14, v50, v51 row_ror:8 row_mask:0x1 bank_mask:0xc
    v_add_f32_dpp v15, v54, v55 row_ror:8 row_mask:0x1 bank_mask:0xc
    v_add_f32_dpp v116, v57, v56 row_ror:8 row_mask:0x2 bank_mask:0x3
    v_add_f32_dpp v118, v61, v60 row_ror:8 row_mask:0x2 bank_mask:0x3
    v_add_f32_dpp v14, v58, v59 row_ror:8 row_mask:0x2 bank_mask:0xc
    v_add_f32_dpp v15, v62, v63 row_ror:8 row_mask:0x2 bank_mask:0xc
    v_add_f32_dpp v116, v65, v64 row_ror:8 row_mask:0x4 bank_mask:0x3
    v_add_f32_dpp v118, v69, v68 row_ror:8 row_mask:0x4 bank_mask:0x3
    v_add_f32_dpp v14, v66, v67 row_ror:8 row_mask:0x4 bank_mask:0xc
    v_add_f32_dpp v15, v70, v71 row_ror:8 row_mask:0x4 bank_mask:0xc
    v_add_f32_dpp v116, v73, v72 row_ror:8 row_mask:0x8 bank_mask:0x3
    v_add_f32_dpp v118, v77, v76 row_ror:8 row_mask:0x8 bank_mask:0x3
    v_add_f32_dpp v14, v74, v75 row_ror:8 row_mask:0x8 bank_mask:0xc
    v_add_f32_dpp v15, v78, v79 row_ror:8 row_mask:0x8 bank_mask:0xc
    s_nop 0
    v_mov_b32_dpp v116, v14 quad_perm:[0,1,2,3] row_mask:0xf bank_mask:0xc
    v_mov_b32_dpp v118, v15 quad_perm:[0,1,2,3] row_mask:0xf bank_mask:0xc
    buffer_store_dwordx4 v[116:119], v13, s[36:39], s14 offen sc1
L_dw_69:
    s_branch L_FIN
L_T_R:
    s_cmp_ge_u32 s3, 8
    s_cbranch_scc1 L_T_R_B
    buffer_load_ushort v12, v7, s[40:43], 0 offen
    s_cmp_ge_u32 s3, 7
    s_cbranch_scc1 L_if_70
    buffer_load_dwordx4 v[80:83], v126, s[36:39], s100 offen sc1
    s_mov_b32 s57, 20000
    s_waitcnt vmcnt(0)
    s_branch L_mpc_73
L_mp_71:
    s_sleep 1
    buffer_load_dwordx4 v[80:83], v126, s[36:39], s100 offen sc1
    s_waitcnt vmcnt(0)
L_mpc_73:
    v_cmp_ne_u32 vcc, s48, v81
    v_cmp_ne_u32 s[98:99], s48, v83
    s_nop 0
    s_or_b64 vcc, vcc, s[98:99]
    s_cbranch_scc0 L_mpd_72
    s_mov_b64 exec, vcc
    s_sub_u32 s57, s57, 1
    s_cmp_lg_u32 s57, 0
    s_cbranch_scc1 L_mp_71
L_mpd_72:
    s_mov_b64 exec, -1
    v_mov_b32 v84, v80
    v_mov_b32 v85, v82
    s_nop 0
    v_permlane16_swap_b32 v80, v84
    v_permlane16_swap_b32 v82, v85
    v_add_f32 v80, v80, v84
    v_add_f32 v82, v82, v85
    v_mov_b32 v84, v80
    v_mov_b32 v85, v82
    s_nop 0
    v_permlane32_swap_b32 v80, v84
    v_permlane32_swap_b32 v82, v85
    v_add_f32 v80, v80, v84
    v_add_f32 v82, v82, v85
    v_mov_b32 v81, v82
    s_mov_b32 exec_lo, 0xffff
    s_mov_b32 exec_hi, 0
    ds_write_b64 v8, v[80:81] offset:2048
    s_mov_b64 exec, -1
L_if_70:
    s_waitcnt lgkmcnt(0)
    s_barrier
    buffer_load_dwordx4 v[88:91], v126, s[36:39], s101 offen sc1
    buffer_load_dwordx4 v[92:95], v126, s[36:39], s101 offen offset:1024 sc1
    s_cmp_lg_u32 s3, 0
    s_cbranch_scc1 L_if_74
    v_and_b32 v11, 31, v1
    v_lshlrev_b32 v11, 2, v11
    v_add_u32 v11, 136448, v11
    ds_read_b32 v96, v11 offset:0
    ds_read_b32 v97, v11 offset:128
    ds_read_b32 v98, v11 offset:256
    ds_read_b32 v99, v11 offset:384
    ds_read_b32 v100, v11 offset:512
    ds_read_b32 v101, v11 offset:640
    ds_read_b32 v102, v11 offset:768
    s_waitcnt lgkmcnt(0)
    v_add_f32 v96, v96, v97
    v_add_f32 v98, v98, v99
    v_add_f32 v100, v100, v101
    v_add_f32 v96, v96, v98
    v_add_f32 v100, v100, v102
    v_add_f32 v96, v96, v100
    v_cvt_pk_bf16_f32 v96, v96, v96
    v_lshlrev_b32 v96, 16, v96
    v_mul_f32 v97, 0xbfb8aa3b, v96
    v_exp_f32 v97, v97
    s_nop 0
    v_add_f32 v97, 1.0, v97
    v_rcp_f32 v97, v97
    s_nop 0
    v_mul_f32 v96, v96, v97
    v_cvt_pk_bf16_f32 v13, v96, v96
    v_lshlrev_b32 v13, 16, v13
L_if_74:
    s_mov_b32 s57, 20000
    s_sleep 6
    buffer_load_dwordx4 v[96:99], v126, s[36:39], s101 offen sc1
    buffer_load_dwordx4 v[100:103], v126, s[36:39], s101 offen offset:1024 sc1
    s_sleep 6
    buffer_load_dwordx4 v[104:107], v126, s[36:39], s101 offen sc1
    buffer_load_dwordx4 v[108:111], v126, s[36:39], s101 offen offset:1024 sc1
L_rp_75:
    s_waitcnt vmcnt(4)
    v_cmp_ne_u32 vcc, s48, v89
    v_cmp_ne_u32 s[98:99], s48, v91
    v_cmp_ne_u32 s[64:65], s48, v93
    v_cmp_ne_u32 s[66:67], s48, v95
    s_or_b64 vcc, vcc, s[98:99]
    s_or_b64 s[64:65], s[64:65], s[66:67]
    s_or_b64 vcc, vcc, s[64:65]
    s_cbranch_scc0 L_rok_77
    buffer_load_dwordx4 v[88:91], v126, s[36:39], s101 offen sc1
    buffer_load_dwordx4 v[92:95], v126, s[36:39], s101 offen offset:1024 sc1
    s_waitcnt vmcnt(4)
    v_cmp_ne_u32 vcc, s48, v97
    v_cmp_ne_u32 s[98:99], s48, v99
    v_cmp_ne_u32 s[64:65], s48, v101
    v_cmp_ne_u32 s[66:67], s48, v103
    s_or_b64 vcc, vcc, s[98:99]
    s_or_b64 s[64:65], s[64:65], s[66:67]
    s_or_b64 vcc, vcc, s[64:65]
    s_cbranch_scc0 L_rok_78
    buffer_load_dwordx4 v[96:99], v126, s[36:39], s101 offen sc1
    buffer_load_dwordx4 v[100:103], v126, s[36:39], s101 offen offset:1024 sc1
    s_waitcnt vmcnt(4)
    v_cmp_ne_u32 vcc, s48, v105
    v_cmp_ne_u32 s[98:99], s48, v107
    v_cmp_ne_u32 s[64:65], s48, v109
    v_cmp_ne_u32 s[66:67], s48, v111
    s_or_b64 vcc, vcc, s[98:99]
    s_or_b64 s[64:65], s[64:65], s[66:67]
    s_or_b64 vcc, vcc, s[64:65]
    s_cbranch_scc0 L_rok_79
    buffer_load_dwordx4 v[104:107], v126, s[36:39], s101 offen sc1
    buffer_load_dwordx4 v[108:111], v126, s[36:39], s101 offen offset:1024 sc1
    s_sub_u32 s57, s57, 1
    s_cmp_lg_u32 s57, 0
    s_cbranch_scc1 L_rp_75
L_rok_77:
    v_add_f32 v86, v88, v92
    v_add_f32 v87, v90, v94
    s_branch L_rpd_76
L_rok_78:
    v_add_f32 v86, v96, v100
    v_add_f32 v87, v98, v102
    s_branch L_rpd_76
L_rok_79:
    v_add_f32 v86, v104, v108
    v_add_f32 v87, v106, v110
L_rpd_76:
    v_mov_b32 v84, v86
    v_mov_b32 v85, v87
    s_nop 0
    v_permlane16_swap_b32 v86, v84
    v_permlane16_swap_b32 v87, v85
    v_add_f32 v86, v86, v84
    v_add_f32 v87, v87, v85
    v_mov_b32 v84, v86
    v_mov_b32 v85, v87
    s_nop 0
    v_permlane32_swap_b32 v86, v84
    v_permlane32_swap_b32 v87, v85
    v_add_f32 v86, v86, v84
    v_add_f32 v87, v87, v85
    s_mov_b32 exec_lo, 0xffff
    s_mov_b32 exec_hi, 0
    ds_write_b64 v8, v[86:87]
    s_mov_b64 exec, -1
    s_waitcnt lgkmcnt(0)
    s_barrier
    s_cmp_lg_u32 s3, 0
    s_cbranch_scc1 L_if_80
    ds_read_b32 v80, v9 offset:0
    ds_read_b32 v81, v9 offset:128
    ds_read_b32 v82, v9 offset:256
    ds_read_b32 v83, v9 offset:384
    v_lshlrev_b32 v12, 16, v12
    s_waitcnt lgkmcnt(0)
    v_add_f32 v80, v80, v82
    v_add_f32 v81, v81, v83
    v_add_f32 v80, v80, v81
    v_mov_b32 v81, v80
    s_nop 1
    v_permlane32_swap_b32 v80, v81
    v_add_f32 v80, v80, v81
    v_cvt_pk_bf16_f32 v80, v80, v80
    v_lshlrev_b32 v80, 16, v80
    v_mul_f32 v80, v80, v13
    v_cvt_pk_bf16_f32 v80, v80, v80
    v_lshlrev_b32 v80, 16, v80
    v_add_f32 v80, v12, v80
    v_cvt_pk_bf16_f32 v80, v80, v80
    s_mov_b32 exec_lo, 0xffffffff
    s_mov_b32 exec_hi, 0
    buffer_store_short v80, v7, s[44:47], 0 offen
    s_mov_b64 exec, -1
    s_cmp_lg_u32 s52, 0
    s_cbranch_scc1 L_if_81
    v_mov_b32 v11, s48
    v_mov_b32 v14, 0
    s_mov_b64 exec, 1
    buffer_store_dword v11, v14, s[36:39], 0 offen sc1
    s_mov_b64 exec, -1
L_if_81:
L_if_80:
    s_branch L_FIN
L_T_R_B:
    s_barrier
    s_barrier
L_FIN:
L_exit:
    s_endpgm
.section .rodata,"a"
.p2align 6
.amdhsa_kernel recurrent_scan__sliding_block_cached__glu_gated_bilinear__decode_kernel
  .amdhsa_next_free_vgpr 128
  .amdhsa_next_free_sgpr 102
  .amdhsa_accum_offset 128
  .amdhsa_group_segment_fixed_size 0
  .amdhsa_kernarg_size 96
  .amdhsa_user_sgpr_count 2
  .amdhsa_user_sgpr_kernarg_segment_ptr 1
  .amdhsa_system_sgpr_workgroup_id_x 1
.end_amdhsa_kernel
```
